```python
import torch

def _softmax(x, axis=-1):
    return torch.softmax(x, dim=axis)

def _gelu(x):
    return torch.nn.functional.gelu(x, approximate='tanh')

def _silu(x):
    return torch.nn.functional.silu(x)

def _sigmoid(x):
    return torch.sigmoid(x)

def _layernorm(x, axis=-1, eps=1e-05):
    m = x.mean(dim=axis, keepdim=True)
    v = x.var(dim=axis, keepdim=True, unbiased=False)
    return (x - m) / torch.sqrt(v + eps)

def _scatter_add(tgt, idx, src, axis=0):
    return tgt.clone().index_add_(axis, idx, src)

def _segment_sum(src, seg, n):
    out = torch.zeros((n,) + src.shape[1:], dtype=src.dtype)
    return out.index_add_(0, seg, src)

def _pad(x, pw):
    flat = tuple((v for pair in reversed(pw) for v in pair))
    return torch.nn.functional.pad(x, flat)
kernel_name = 'adaLN_cond__gqa_block_cached__mixer_channel_mlp__decode'

def setup_inputs():

    _w = lambda a: (lambda t: t.to(torch.bfloat16) if t.is_floating_point() else t)(torch.as_tensor(a))

    def _A_setup():
        B, Sq, D = (2, 1, 1024)
        Hq, Hkv, Sk, Dh = (32, 4, 32768, 128)
        assert Hq % Hkv == 0, (Hq, Hkv)
        return {'x': _w((lambda *s: torch.randn(*s, dtype=torch.bfloat16) * 0.1)(B, Sq, D)), 'k_cache': _w((lambda *s: torch.randn(*s, dtype=torch.bfloat16) * 1.6)(B, Hkv, Sk, Dh)), 'v_cache': _w((lambda *s: torch.randn(*s, dtype=torch.bfloat16) * 0.8)(B, Hkv, Sk, Dh)), 'wq': _w((lambda *s: torch.randn(*s, dtype=torch.bfloat16) * 1.6)(D, Hq * Dh) * D ** (-0.5)), 'wo': _w((lambda *s: torch.randn(*s, dtype=torch.bfloat16) * 0.8)(Hq * Dh, D) * (Hq * Dh) ** (-0.5))}
    _A_in = _A_setup()

    def _B_setup():
        B, S, D, F = (2, 1, 1024, 3584)
        return {'x': _w((lambda *s: torch.randn(*s, dtype=torch.bfloat16) * 0.1)(B, S, D)), 'w1': _w((lambda *s: torch.randn(*s, dtype=torch.bfloat16) * 3.2)(D, F) * D ** (-0.5)), 'b1': _w((lambda *s: torch.randn(*s, dtype=torch.bfloat16) * 3.2)(F)), 'w2': _w((lambda *s: torch.randn(*s, dtype=torch.bfloat16) * 3.2)(F, D) * F ** (-0.5)), 'b2': _w((lambda *s: torch.randn(*s, dtype=torch.bfloat16) * 3.2)(D))}
    _B_in = _B_setup()
    return {'A_x': _A_in['x'], 'A_k_cache': _A_in['k_cache'], 'A_v_cache': _A_in['v_cache'], 'A_wq': _A_in['wq'], 'A_wo': _A_in['wo'], 'B_x': _B_in['x'], 'B_w1': _B_in['w1'], 'B_b1': _B_in['b1'], 'B_w2': _B_in['w2'], 'B_b2': _B_in['b2'], 'c': _w((lambda *s: torch.randn(*s, dtype=torch.bfloat16) * 0.2)(2, 1024) * 8.0), 'w_mod': _w((lambda *s: torch.randn(*s, dtype=torch.bfloat16) * 0.2)(1024, 6 * 1024) * 1024 ** (-0.5) * 8.0)}

def reference(A_x, A_k_cache, A_v_cache, A_wq, A_wo, B_x, B_w1, B_b1, B_w2, B_b2, c, w_mod):

    def _A_ref(x, k_cache, v_cache, wq, wo):
        B, Sq, D = x.shape
        Hq, Dh = (32, 128)
        Hkv = k_cache.shape[1]
        rep = Hq // Hkv
        q = (lambda x, *d: x.permute(*d))((x @ wq).reshape(B, Sq, Hq, Dh), 0, 2, 1, 3)
        k = (lambda x, n, axis: torch.repeat_interleave(x, n, dim=axis))(k_cache, rep, axis=1)
        v = (lambda x, n, axis: torch.repeat_interleave(x, n, dim=axis))(v_cache, rep, axis=1)
        scores = torch.einsum('bhqd,bhkd->bhqk', q, k) * Dh ** (-0.5)
        p = _softmax(scores, axis=-1)
        o = torch.einsum('bhqk,bhkd->bhqd', p, v)
        return (lambda x, *d: x.permute(*d))(o, 0, 2, 1, 3).reshape(B, Sq, Hq * Dh) @ wo

    def _B_ref(x, w1, b1, w2, b2):
        y = _layernorm(x, axis=-1)
        h = _gelu(torch.einsum('bsd,df->bsf', y, w1) + b1)
        return torch.einsum('bsf,fd->bsd', h, w2) + b2
    x = A_x
    mod = (_silu(c) @ w_mod).reshape(c.shape[0], 6, 1, -1)
    sa, ca, ga, sb, cb, gb = (mod[:, 0].clone(), mod[:, 1].clone(), mod[:, 2].clone(), mod[:, 3].clone(), mod[:, 4].clone(), mod[:, 5].clone())
    h = _layernorm(x, axis=-1) * (1 + ca) + sa
    x = x + ga * _A_ref(h, A_k_cache, A_v_cache, A_wq, A_wo)
    h = _layernorm(x, axis=-1) * (1 + cb) + sb
    x = x + gb * _B_ref(h, B_w1, B_b1, B_w2, B_b2)
    return x
```

```asm
; @launch grid=(256,1,1) block=(768,1,1) lds=113664
.amdgcn_target "amdgcn-amd-amdhsa--gfx950"
.text
.globl adaLN_cond__gqa_block_cached__mixer_channel_mlp__decode_kernel
.p2align 8
.type adaLN_cond__gqa_block_cached__mixer_channel_mlp__decode_kernel,@function
adaLN_cond__gqa_block_cached__mixer_channel_mlp__decode_kernel:
    s_cmp_ge_u32 s2, 256
    s_cbranch_scc1 L_end
    s_load_dwordx16 s[16:31], s[0:1], 0
    s_load_dwordx8 s[32:39], s[0:1], 64
    s_load_dwordx2 s[40:41], s[0:1], 96
    s_load_dwordx2 s[42:43], s[0:1], 112
    v_lshrrev_b32 v4, 6, v0
    v_and_b32 v1, 63, v0
    v_readfirstlane_b32 s100, v4
    s_and_b32 s5, s2, 7
    s_lshr_b32 s6, s2, 3
    s_lshl_b32 s4, s5, 5
    s_add_u32 s4, s4, s6
    s_lshr_b32 s7, s6, 1
    s_lshr_b32 s9, s7, 2
    s_lshl_b32 s9, s9, 3
    s_add_u32 s9, s9, s5
    s_lshl_b32 s86, s9, 2
    s_and_b32 s9, s7, 3
    s_add_u32 s86, s86, s9
    s_mov_b32 s76, 0x05040100
    s_mov_b32 s77, 0x07060302
    s_mov_b32 s78, 0xffff0000
    s_mov_b32 s79, 0x3fb8aa3b
    s_mov_b32 s80, 0x3db504f3
    s_mov_b32 s83, 1023
    v_lshrrev_b32 v7, 3, v1
    s_sub_u32 s3, s100, 4
    s_cmp_lg_u32 s100, 0
    s_cbranch_scc1 L_noinit
    v_lshlrev_b32 v4, 2, v1
    v_add_u32 v4, 101888, v4
    v_mov_b32 v5, 0
    ds_write_b32 v4, v5
    ds_write_b32 v4, v5 offset:9600
L_noinit:
    s_cmp_eq_u32 s100, 1
    s_cbranch_scc1 L_moda
    s_cmp_ge_u32 s100, 4
    s_cbranch_scc1 L_att
    s_cmp_eq_u32 s100, 0
    s_cbranch_scc1 L_chain
    s_cmp_eq_u32 s100, 2
    s_cbranch_scc1 L_red
    s_cmp_lt_u32 s6, 30
    s_cbranch_scc1 Lnowarm_1
    s_getpc_b64 s[10:11]
L_pc0:
    v_lshlrev_b32 v8, 4, v1
    s_mov_b32 s9, 0
Lwarm_2:
    v_min_u32 v9, L_end-L_pc0-16, v8
    global_load_dwordx4 v[64:67], v9, s[10:11]
    v_add_u32 v8, 1024, v8
    s_add_u32 s9, s9, 1024
    s_cmp_lt_u32 s9, L_end-L_pc0
    s_cbranch_scc1 Lwarm_2
Lnowarm_1:
    v_lshrrev_b32 v11, 4, v1
    s_mov_b32 s9, 98304
    v_mul_lo_u32 v8, v11, s9
    v_and_b32 v9, 15, v1
    v_lshl_add_u32 v8, v9, 4, v8
    v_and_b32 v6, 1, v1
    v_lshlrev_b32 v10, 11, v6
    v_lshl_add_u32 v10, v11, 4, v10
    s_and_b32 s12, s6, 7
    s_lshr_b32 s14, s6, 3
    s_mul_i32 s10, s12, 1572864
    s_lshl_b32 s14, s14, 3
    s_add_u32 s14, s14, s5
    s_lshl_b32 s9, s14, 8
    s_add_u32 s10, s10, s9
    s_add_u32 s10, s10, 4096
    s_lshl_b32 s11, s12, 8
    s_lshl_b32 s15, s12, 15
    s_lshl_b32 s9, s14, 9
    s_add_u32 s15, s15, s9
    s_add_u32 s15, s15, 1310720
    s_waitcnt lgkmcnt(0)
    s_load_dword s82, s[42:43], 0
    s_mov_b32 s52, s42
    s_mov_b32 s53, s43
    s_mov_b32 s54, 268435456
    s_mov_b32 s55, 0x20000
    s_mov_b32 s56, s38
    s_mov_b32 s57, s39
    s_mov_b32 s58, 12582912
    s_mov_b32 s59, 0x20000
    s_mov_b32 s60, s36
    s_mov_b32 s61, s37
    s_mov_b32 s62, 4096
    s_mov_b32 s63, 0x20000
    s_barrier
    buffer_load_dwordx4 v[16:19], v10, s[60:63], s11 offen offset:0
    buffer_load_dwordx4 v[20:23], v10, s[60:63], s11 offen offset:64
    buffer_load_dwordx4 v[24:27], v10, s[60:63], s11 offen offset:128
    buffer_load_dwordx4 v[28:31], v10, s[60:63], s11 offen offset:192
    s_add_u32 s9, s10, 0
    buffer_load_dwordx4 v[72:75], v8, s[56:59], s9 offen nt
    s_add_u32 s9, s10, 12288
    buffer_load_dwordx4 v[76:79], v8, s[56:59], s9 offen nt
    s_add_u32 s9, s10, 24576
    buffer_load_dwordx4 v[80:83], v8, s[56:59], s9 offen nt
    s_add_u32 s9, s10, 36864
    buffer_load_dwordx4 v[84:87], v8, s[56:59], s9 offen nt
    s_add_u32 s9, s10, 49152
    buffer_load_dwordx4 v[88:91], v8, s[56:59], s9 offen nt
    s_add_u32 s9, s10, 61440
    buffer_load_dwordx4 v[92:95], v8, s[56:59], s9 offen nt
    s_add_u32 s9, s10, 73728
    buffer_load_dwordx4 v[96:99], v8, s[56:59], s9 offen nt
    s_add_u32 s9, s10, 86016
    buffer_load_dwordx4 v[100:103], v8, s[56:59], s9 offen nt
    s_add_u32 s9, s10, 393216
    buffer_load_dwordx4 v[104:107], v8, s[56:59], s9 offen nt
    s_add_u32 s9, s10, 405504
    buffer_load_dwordx4 v[108:111], v8, s[56:59], s9 offen nt
    s_add_u32 s9, s10, 417792
    buffer_load_dwordx4 v[112:115], v8, s[56:59], s9 offen nt
    s_add_u32 s9, s10, 430080
    buffer_load_dwordx4 v[116:119], v8, s[56:59], s9 offen nt
    s_add_u32 s9, s10, 442368
    buffer_load_dwordx4 v[120:123], v8, s[56:59], s9 offen nt
    s_add_u32 s9, s10, 454656
    buffer_load_dwordx4 v[124:127], v8, s[56:59], s9 offen nt
    s_add_u32 s9, s10, 466944
    buffer_load_dwordx4 v[128:131], v8, s[56:59], s9 offen nt
    s_add_u32 s9, s10, 479232
    buffer_load_dwordx4 v[132:135], v8, s[56:59], s9 offen nt
    s_add_u32 s9, s10, 786432
    buffer_load_dwordx4 v[136:139], v8, s[56:59], s9 offen nt
    s_add_u32 s9, s10, 798720
    buffer_load_dwordx4 v[140:143], v8, s[56:59], s9 offen nt
    s_add_u32 s9, s10, 811008
    buffer_load_dwordx4 v[144:147], v8, s[56:59], s9 offen nt
    s_add_u32 s9, s10, 823296
    buffer_load_dwordx4 v[148:151], v8, s[56:59], s9 offen nt
    s_add_u32 s9, s10, 835584
    buffer_load_dwordx4 v[152:155], v8, s[56:59], s9 offen nt
    s_add_u32 s9, s10, 847872
    buffer_load_dwordx4 v[156:159], v8, s[56:59], s9 offen nt
    s_add_u32 s9, s10, 860160
    buffer_load_dwordx4 v[160:163], v8, s[56:59], s9 offen nt
    s_add_u32 s9, s10, 872448
    buffer_load_dwordx4 v[164:167], v8, s[56:59], s9 offen nt
    s_waitcnt lgkmcnt(0)
    s_add_u32 s82, s82, 1
    s_and_b32 s8, s82, 1023
    v_mov_b32 v13, s8
    s_waitcnt vmcnt(24)
    s_mov_b32 s13, 0xbfb8aa3b
    v_lshlrev_b32 v4, 16, v16
    v_and_b32 v5, s78, v16
    v_mul_f32 v2, s13, v4
    v_mul_f32 v3, s13, v5
    v_exp_f32 v2, v2
    v_exp_f32 v3, v3
    v_add_f32 v2, 1.0, v2
    v_add_f32 v3, 1.0, v3
    v_rcp_f32 v2, v2
    v_rcp_f32 v3, v3
    v_mul_f32 v4, v4, v2
    v_mul_f32 v5, v5, v3
    v_cvt_pk_bf16_f32 v16, v4, v5
    v_lshlrev_b32 v4, 16, v17
    v_and_b32 v5, s78, v17
    v_mul_f32 v2, s13, v4
    v_mul_f32 v3, s13, v5
    v_exp_f32 v2, v2
    v_exp_f32 v3, v3
    v_add_f32 v2, 1.0, v2
    v_add_f32 v3, 1.0, v3
    v_rcp_f32 v2, v2
    v_rcp_f32 v3, v3
    v_mul_f32 v4, v4, v2
    v_mul_f32 v5, v5, v3
    v_cvt_pk_bf16_f32 v17, v4, v5
    v_lshlrev_b32 v4, 16, v18
    v_and_b32 v5, s78, v18
    v_mul_f32 v2, s13, v4
    v_mul_f32 v3, s13, v5
    v_exp_f32 v2, v2
    v_exp_f32 v3, v3
    v_add_f32 v2, 1.0, v2
    v_add_f32 v3, 1.0, v3
    v_rcp_f32 v2, v2
    v_rcp_f32 v3, v3
    v_mul_f32 v4, v4, v2
    v_mul_f32 v5, v5, v3
    v_cvt_pk_bf16_f32 v18, v4, v5
    v_lshlrev_b32 v4, 16, v19
    v_and_b32 v5, s78, v19
    v_mul_f32 v2, s13, v4
    v_mul_f32 v3, s13, v5
    v_exp_f32 v2, v2
    v_exp_f32 v3, v3
    v_add_f32 v2, 1.0, v2
    v_add_f32 v3, 1.0, v3
    v_rcp_f32 v2, v2
    v_rcp_f32 v3, v3
    v_mul_f32 v4, v4, v2
    v_mul_f32 v5, v5, v3
    v_cvt_pk_bf16_f32 v19, v4, v5
    s_waitcnt vmcnt(16)
    v_perm_b32 v64, v76, v72, s76
    v_perm_b32 v65, v84, v80, s76
    v_perm_b32 v66, v92, v88, s76
    v_perm_b32 v67, v100, v96, s76
    s_nop 1
    v_mfma_f32_16x16x32_bf16 v[32:35], v[64:67], v[16:19], 0
    v_perm_b32 v68, v76, v72, s77
    v_perm_b32 v69, v84, v80, s77
    v_perm_b32 v70, v92, v88, s77
    v_perm_b32 v71, v100, v96, s77
    s_nop 1
    v_mfma_f32_16x16x32_bf16 v[36:39], v[68:71], v[16:19], 0
    v_perm_b32 v64, v77, v73, s76
    v_perm_b32 v65, v85, v81, s76
    v_perm_b32 v66, v93, v89, s76
    v_perm_b32 v67, v101, v97, s76
    s_nop 1
    v_mfma_f32_16x16x32_bf16 v[40:43], v[64:67], v[16:19], 0
    v_perm_b32 v68, v77, v73, s77
    v_perm_b32 v69, v85, v81, s77
    v_perm_b32 v70, v93, v89, s77
    v_perm_b32 v71, v101, v97, s77
    s_nop 1
    v_mfma_f32_16x16x32_bf16 v[44:47], v[68:71], v[16:19], 0
    v_perm_b32 v64, v78, v74, s76
    v_perm_b32 v65, v86, v82, s76
    v_perm_b32 v66, v94, v90, s76
    v_perm_b32 v67, v102, v98, s76
    s_nop 1
    v_mfma_f32_16x16x32_bf16 v[48:51], v[64:67], v[16:19], 0
    v_perm_b32 v68, v78, v74, s77
    v_perm_b32 v69, v86, v82, s77
    v_perm_b32 v70, v94, v90, s77
    v_perm_b32 v71, v102, v98, s77
    s_nop 1
    v_mfma_f32_16x16x32_bf16 v[52:55], v[68:71], v[16:19], 0
    v_perm_b32 v64, v79, v75, s76
    v_perm_b32 v65, v87, v83, s76
    v_perm_b32 v66, v95, v91, s76
    v_perm_b32 v67, v103, v99, s76
    s_nop 1
    v_mfma_f32_16x16x32_bf16 v[56:59], v[64:67], v[16:19], 0
    v_perm_b32 v68, v79, v75, s77
    v_perm_b32 v69, v87, v83, s77
    v_perm_b32 v70, v95, v91, s77
    v_perm_b32 v71, v103, v99, s77
    s_nop 1
    v_mfma_f32_16x16x32_bf16 v[60:63], v[68:71], v[16:19], 0
    s_add_u32 s9, s10, 1179648
    buffer_load_dwordx4 v[72:75], v8, s[56:59], s9 offen nt
    s_add_u32 s9, s10, 1191936
    buffer_load_dwordx4 v[76:79], v8, s[56:59], s9 offen nt
    s_add_u32 s9, s10, 1204224
    buffer_load_dwordx4 v[80:83], v8, s[56:59], s9 offen nt
    s_add_u32 s9, s10, 1216512
    buffer_load_dwordx4 v[84:87], v8, s[56:59], s9 offen nt
    s_add_u32 s9, s10, 1228800
    buffer_load_dwordx4 v[88:91], v8, s[56:59], s9 offen nt
    s_add_u32 s9, s10, 1241088
    buffer_load_dwordx4 v[92:95], v8, s[56:59], s9 offen nt
    s_add_u32 s9, s10, 1253376
    buffer_load_dwordx4 v[96:99], v8, s[56:59], s9 offen nt
    s_add_u32 s9, s10, 1265664
    buffer_load_dwordx4 v[100:103], v8, s[56:59], s9 offen nt
    v_lshlrev_b32 v4, 16, v20
    v_and_b32 v5, s78, v20
    v_mul_f32 v2, s13, v4
    v_mul_f32 v3, s13, v5
    v_exp_f32 v2, v2
    v_exp_f32 v3, v3
    v_add_f32 v2, 1.0, v2
    v_add_f32 v3, 1.0, v3
    v_rcp_f32 v2, v2
    v_rcp_f32 v3, v3
    v_mul_f32 v4, v4, v2
    v_mul_f32 v5, v5, v3
    v_cvt_pk_bf16_f32 v20, v4, v5
    v_lshlrev_b32 v4, 16, v21
    v_and_b32 v5, s78, v21
    v_mul_f32 v2, s13, v4
    v_mul_f32 v3, s13, v5
    v_exp_f32 v2, v2
    v_exp_f32 v3, v3
    v_add_f32 v2, 1.0, v2
    v_add_f32 v3, 1.0, v3
    v_rcp_f32 v2, v2
    v_rcp_f32 v3, v3
    v_mul_f32 v4, v4, v2
    v_mul_f32 v5, v5, v3
    v_cvt_pk_bf16_f32 v21, v4, v5
    v_lshlrev_b32 v4, 16, v22
    v_and_b32 v5, s78, v22
    v_mul_f32 v2, s13, v4
    v_mul_f32 v3, s13, v5
    v_exp_f32 v2, v2
    v_exp_f32 v3, v3
    v_add_f32 v2, 1.0, v2
    v_add_f32 v3, 1.0, v3
    v_rcp_f32 v2, v2
    v_rcp_f32 v3, v3
    v_mul_f32 v4, v4, v2
    v_mul_f32 v5, v5, v3
    v_cvt_pk_bf16_f32 v22, v4, v5
    v_lshlrev_b32 v4, 16, v23
    v_and_b32 v5, s78, v23
    v_mul_f32 v2, s13, v4
    v_mul_f32 v3, s13, v5
    v_exp_f32 v2, v2
    v_exp_f32 v3, v3
    v_add_f32 v2, 1.0, v2
    v_add_f32 v3, 1.0, v3
    v_rcp_f32 v2, v2
    v_rcp_f32 v3, v3
    v_mul_f32 v4, v4, v2
    v_mul_f32 v5, v5, v3
    v_cvt_pk_bf16_f32 v23, v4, v5
    s_waitcnt vmcnt(16)
    v_perm_b32 v64, v108, v104, s76
    v_perm_b32 v65, v116, v112, s76
    v_perm_b32 v66, v124, v120, s76
    v_perm_b32 v67, v132, v128, s76
    s_nop 1
    v_mfma_f32_16x16x32_bf16 v[32:35], v[64:67], v[20:23], v[32:35]
    v_perm_b32 v68, v108, v104, s77
    v_perm_b32 v69, v116, v112, s77
    v_perm_b32 v70, v124, v120, s77
    v_perm_b32 v71, v132, v128, s77
    s_nop 1
    v_mfma_f32_16x16x32_bf16 v[36:39], v[68:71], v[20:23], v[36:39]
    v_perm_b32 v64, v109, v105, s76
    v_perm_b32 v65, v117, v113, s76
    v_perm_b32 v66, v125, v121, s76
    v_perm_b32 v67, v133, v129, s76
    s_nop 1
    v_mfma_f32_16x16x32_bf16 v[40:43], v[64:67], v[20:23], v[40:43]
    v_perm_b32 v68, v109, v105, s77
    v_perm_b32 v69, v117, v113, s77
    v_perm_b32 v70, v125, v121, s77
    v_perm_b32 v71, v133, v129, s77
    s_nop 1
    v_mfma_f32_16x16x32_bf16 v[44:47], v[68:71], v[20:23], v[44:47]
    v_perm_b32 v64, v110, v106, s76
    v_perm_b32 v65, v118, v114, s76
    v_perm_b32 v66, v126, v122, s76
    v_perm_b32 v67, v134, v130, s76
    s_nop 1
    v_mfma_f32_16x16x32_bf16 v[48:51], v[64:67], v[20:23], v[48:51]
    v_perm_b32 v68, v110, v106, s77
    v_perm_b32 v69, v118, v114, s77
    v_perm_b32 v70, v126, v122, s77
    v_perm_b32 v71, v134, v130, s77
    s_nop 1
    v_mfma_f32_16x16x32_bf16 v[52:55], v[68:71], v[20:23], v[52:55]
    v_perm_b32 v64, v111, v107, s76
    v_perm_b32 v65, v119, v115, s76
    v_perm_b32 v66, v127, v123, s76
    v_perm_b32 v67, v135, v131, s76
    s_nop 1
    v_mfma_f32_16x16x32_bf16 v[56:59], v[64:67], v[20:23], v[56:59]
    v_perm_b32 v68, v111, v107, s77
    v_perm_b32 v69, v119, v115, s77
    v_perm_b32 v70, v127, v123, s77
    v_perm_b32 v71, v135, v131, s77
    s_nop 1
    v_mfma_f32_16x16x32_bf16 v[60:63], v[68:71], v[20:23], v[60:63]
    v_lshlrev_b32 v4, 16, v24
    v_and_b32 v5, s78, v24
    v_mul_f32 v2, s13, v4
    v_mul_f32 v3, s13, v5
    v_exp_f32 v2, v2
    v_exp_f32 v3, v3
    v_add_f32 v2, 1.0, v2
    v_add_f32 v3, 1.0, v3
    v_rcp_f32 v2, v2
    v_rcp_f32 v3, v3
    v_mul_f32 v4, v4, v2
    v_mul_f32 v5, v5, v3
    v_cvt_pk_bf16_f32 v24, v4, v5
    v_lshlrev_b32 v4, 16, v25
    v_and_b32 v5, s78, v25
    v_mul_f32 v2, s13, v4
    v_mul_f32 v3, s13, v5
    v_exp_f32 v2, v2
    v_exp_f32 v3, v3
    v_add_f32 v2, 1.0, v2
    v_add_f32 v3, 1.0, v3
    v_rcp_f32 v2, v2
    v_rcp_f32 v3, v3
    v_mul_f32 v4, v4, v2
    v_mul_f32 v5, v5, v3
    v_cvt_pk_bf16_f32 v25, v4, v5
    v_lshlrev_b32 v4, 16, v26
    v_and_b32 v5, s78, v26
    v_mul_f32 v2, s13, v4
    v_mul_f32 v3, s13, v5
    v_exp_f32 v2, v2
    v_exp_f32 v3, v3
    v_add_f32 v2, 1.0, v2
    v_add_f32 v3, 1.0, v3
    v_rcp_f32 v2, v2
    v_rcp_f32 v3, v3
    v_mul_f32 v4, v4, v2
    v_mul_f32 v5, v5, v3
    v_cvt_pk_bf16_f32 v26, v4, v5
    v_lshlrev_b32 v4, 16, v27
    v_and_b32 v5, s78, v27
    v_mul_f32 v2, s13, v4
    v_mul_f32 v3, s13, v5
    v_exp_f32 v2, v2
    v_exp_f32 v3, v3
    v_add_f32 v2, 1.0, v2
    v_add_f32 v3, 1.0, v3
    v_rcp_f32 v2, v2
    v_rcp_f32 v3, v3
    v_mul_f32 v4, v4, v2
    v_mul_f32 v5, v5, v3
    v_cvt_pk_bf16_f32 v27, v4, v5
    s_waitcnt vmcnt(8)
    v_perm_b32 v64, v140, v136, s76
    v_perm_b32 v65, v148, v144, s76
    v_perm_b32 v66, v156, v152, s76
    v_perm_b32 v67, v164, v160, s76
    s_nop 1
    v_mfma_f32_16x16x32_bf16 v[32:35], v[64:67], v[24:27], v[32:35]
    v_perm_b32 v68, v140, v136, s77
    v_perm_b32 v69, v148, v144, s77
    v_perm_b32 v70, v156, v152, s77
    v_perm_b32 v71, v164, v160, s77
    s_nop 1
    v_mfma_f32_16x16x32_bf16 v[36:39], v[68:71], v[24:27], v[36:39]
    v_perm_b32 v64, v141, v137, s76
    v_perm_b32 v65, v149, v145, s76
    v_perm_b32 v66, v157, v153, s76
    v_perm_b32 v67, v165, v161, s76
    s_nop 1
    v_mfma_f32_16x16x32_bf16 v[40:43], v[64:67], v[24:27], v[40:43]
    v_perm_b32 v68, v141, v137, s77
    v_perm_b32 v69, v149, v145, s77
    v_perm_b32 v70, v157, v153, s77
    v_perm_b32 v71, v165, v161, s77
    s_nop 1
    v_mfma_f32_16x16x32_bf16 v[44:47], v[68:71], v[24:27], v[44:47]
    v_perm_b32 v64, v142, v138, s76
    v_perm_b32 v65, v150, v146, s76
    v_perm_b32 v66, v158, v154, s76
    v_perm_b32 v67, v166, v162, s76
    s_nop 1
    v_mfma_f32_16x16x32_bf16 v[48:51], v[64:67], v[24:27], v[48:51]
    v_perm_b32 v68, v142, v138, s77
    v_perm_b32 v69, v150, v146, s77
    v_perm_b32 v70, v158, v154, s77
    v_perm_b32 v71, v166, v162, s77
    s_nop 1
    v_mfma_f32_16x16x32_bf16 v[52:55], v[68:71], v[24:27], v[52:55]
    v_perm_b32 v64, v143, v139, s76
    v_perm_b32 v65, v151, v147, s76
    v_perm_b32 v66, v159, v155, s76
    v_perm_b32 v67, v167, v163, s76
    s_nop 1
    v_mfma_f32_16x16x32_bf16 v[56:59], v[64:67], v[24:27], v[56:59]
    v_perm_b32 v68, v143, v139, s77
    v_perm_b32 v69, v151, v147, s77
    v_perm_b32 v70, v159, v155, s77
    v_perm_b32 v71, v167, v163, s77
    s_nop 1
    v_mfma_f32_16x16x32_bf16 v[60:63], v[68:71], v[24:27], v[60:63]
    v_lshlrev_b32 v4, 16, v28
    v_and_b32 v5, s78, v28
    v_mul_f32 v2, s13, v4
    v_mul_f32 v3, s13, v5
    v_exp_f32 v2, v2
    v_exp_f32 v3, v3
    v_add_f32 v2, 1.0, v2
    v_add_f32 v3, 1.0, v3
    v_rcp_f32 v2, v2
    v_rcp_f32 v3, v3
    v_mul_f32 v4, v4, v2
    v_mul_f32 v5, v5, v3
    v_cvt_pk_bf16_f32 v28, v4, v5
    v_lshlrev_b32 v4, 16, v29
    v_and_b32 v5, s78, v29
    v_mul_f32 v2, s13, v4
    v_mul_f32 v3, s13, v5
    v_exp_f32 v2, v2
    v_exp_f32 v3, v3
    v_add_f32 v2, 1.0, v2
    v_add_f32 v3, 1.0, v3
    v_rcp_f32 v2, v2
    v_rcp_f32 v3, v3
    v_mul_f32 v4, v4, v2
    v_mul_f32 v5, v5, v3
    v_cvt_pk_bf16_f32 v29, v4, v5
    v_lshlrev_b32 v4, 16, v30
    v_and_b32 v5, s78, v30
    v_mul_f32 v2, s13, v4
    v_mul_f32 v3, s13, v5
    v_exp_f32 v2, v2
    v_exp_f32 v3, v3
    v_add_f32 v2, 1.0, v2
    v_add_f32 v3, 1.0, v3
    v_rcp_f32 v2, v2
    v_rcp_f32 v3, v3
    v_mul_f32 v4, v4, v2
    v_mul_f32 v5, v5, v3
    v_cvt_pk_bf16_f32 v30, v4, v5
    v_lshlrev_b32 v4, 16, v31
    v_and_b32 v5, s78, v31
    v_mul_f32 v2, s13, v4
    v_mul_f32 v3, s13, v5
    v_exp_f32 v2, v2
    v_exp_f32 v3, v3
    v_add_f32 v2, 1.0, v2
    v_add_f32 v3, 1.0, v3
    v_rcp_f32 v2, v2
    v_rcp_f32 v3, v3
    v_mul_f32 v4, v4, v2
    v_mul_f32 v5, v5, v3
    v_cvt_pk_bf16_f32 v31, v4, v5
    s_waitcnt vmcnt(0)
    v_perm_b32 v64, v76, v72, s76
    v_perm_b32 v65, v84, v80, s76
    v_perm_b32 v66, v92, v88, s76
    v_perm_b32 v67, v100, v96, s76
    s_nop 1
    v_mfma_f32_16x16x32_bf16 v[32:35], v[64:67], v[28:31], v[32:35]
    v_perm_b32 v68, v76, v72, s77
    v_perm_b32 v69, v84, v80, s77
    v_perm_b32 v70, v92, v88, s77
    v_perm_b32 v71, v100, v96, s77
    s_nop 1
    v_mfma_f32_16x16x32_bf16 v[36:39], v[68:71], v[28:31], v[36:39]
    v_perm_b32 v64, v77, v73, s76
    v_perm_b32 v65, v85, v81, s76
    v_perm_b32 v66, v93, v89, s76
    v_perm_b32 v67, v101, v97, s76
    s_nop 1
    v_mfma_f32_16x16x32_bf16 v[40:43], v[64:67], v[28:31], v[40:43]
    v_perm_b32 v68, v77, v73, s77
    v_perm_b32 v69, v85, v81, s77
    v_perm_b32 v70, v93, v89, s77
    v_perm_b32 v71, v101, v97, s77
    s_nop 1
    v_mfma_f32_16x16x32_bf16 v[44:47], v[68:71], v[28:31], v[44:47]
    v_perm_b32 v64, v78, v74, s76
    v_perm_b32 v65, v86, v82, s76
    v_perm_b32 v66, v94, v90, s76
    v_perm_b32 v67, v102, v98, s76
    s_nop 1
    v_mfma_f32_16x16x32_bf16 v[48:51], v[64:67], v[28:31], v[48:51]
    v_perm_b32 v68, v78, v74, s77
    v_perm_b32 v69, v86, v82, s77
    v_perm_b32 v70, v94, v90, s77
    v_perm_b32 v71, v102, v98, s77
    s_nop 1
    v_mfma_f32_16x16x32_bf16 v[52:55], v[68:71], v[28:31], v[52:55]
    v_perm_b32 v64, v79, v75, s76
    v_perm_b32 v65, v87, v83, s76
    v_perm_b32 v66, v95, v91, s76
    v_perm_b32 v67, v103, v99, s76
    s_nop 1
    v_mfma_f32_16x16x32_bf16 v[56:59], v[64:67], v[28:31], v[56:59]
    v_perm_b32 v68, v79, v75, s77
    v_perm_b32 v69, v87, v83, s77
    v_perm_b32 v70, v95, v91, s77
    v_perm_b32 v71, v103, v99, s77
    s_nop 1
    v_mfma_f32_16x16x32_bf16 v[60:63], v[68:71], v[28:31], v[60:63]
    v_bfe_u32 v9, v1, 1, 1
    v_bfe_u32 v10, v1, 2, 2
    v_cmp_eq_u32 vcc, 1, v9
    s_nop 1
    v_cndmask_b32 v32, v32, v48, vcc
    v_cndmask_b32 v33, v33, v49, vcc
    v_cndmask_b32 v34, v34, v50, vcc
    v_cndmask_b32 v35, v35, v51, vcc
    v_cndmask_b32 v36, v36, v52, vcc
    v_cndmask_b32 v37, v37, v53, vcc
    v_cndmask_b32 v38, v38, v54, vcc
    v_cndmask_b32 v39, v39, v55, vcc
    v_cndmask_b32 v40, v40, v56, vcc
    v_cndmask_b32 v41, v41, v57, vcc
    v_cndmask_b32 v42, v42, v58, vcc
    v_cndmask_b32 v43, v43, v59, vcc
    v_cndmask_b32 v44, v44, v60, vcc
    v_cndmask_b32 v45, v45, v61, vcc
    v_cndmask_b32 v46, v46, v62, vcc
    v_cndmask_b32 v47, v47, v63, vcc
    v_cmp_eq_u32 vcc, 1, v10
    s_nop 1
    v_cndmask_b32 v32, v32, v33, vcc
    v_cndmask_b32 v36, v36, v37, vcc
    v_cndmask_b32 v40, v40, v41, vcc
    v_cndmask_b32 v44, v44, v45, vcc
    v_cmp_eq_u32 vcc, 2, v10
    s_nop 1
    v_cndmask_b32 v32, v32, v34, vcc
    v_cndmask_b32 v36, v36, v38, vcc
    v_cndmask_b32 v40, v40, v42, vcc
    v_cndmask_b32 v44, v44, v46, vcc
    v_cmp_eq_u32 vcc, 3, v10
    s_nop 1
    v_cndmask_b32 v32, v32, v35, vcc
    v_cndmask_b32 v36, v36, v39, vcc
    v_cndmask_b32 v40, v40, v43, vcc
    v_cndmask_b32 v44, v44, v47, vcc
    v_add_u32 v16, 0x200, v32
    v_bfi_b32 v16, s83, v13, v16
    v_add_u32 v17, 0x200, v36
    v_bfi_b32 v17, s83, v13, v17
    v_add_u32 v18, 0x200, v40
    v_bfi_b32 v18, s83, v13, v18
    v_add_u32 v19, 0x200, v44
    v_bfi_b32 v19, s83, v13, v19
    v_lshl_add_u32 v10, v11, 2, v10
    v_lshl_add_u32 v9, v10, 1, v9
    v_lshlrev_b32 v9, 4, v9
    v_lshl_add_u32 v9, v6, 14, v9
    v_mov_b32 v4, 111624
    s_mov_b32 s81, 4000000
Lw_3:
    ds_read_b32 v5, v4
    s_waitcnt lgkmcnt(0)
    v_cmp_ne_u32 vcc, 0, v5
    s_cbranch_vccnz Lwd_4
    s_sleep 1
    s_sub_u32 s81, s81, 1
    s_cbranch_scc0 Lw_3
Lwd_4:
    v_readfirstlane_b32 s101, v5
    s_nop 0
    s_cmp_eq_u32 s101, 1
    s_cbranch_scc1 Lsg_5
    buffer_store_dwordx4 v[16:19], v9, s[52:55], s15 offen sc1
    s_branch Lsgd_6
Lsg_5:
    buffer_store_dwordx4 v[16:19], v9, s[52:55], s15 offen
Lsgd_6:
    s_bitcmp1_b32 s6, 0
    s_cbranch_scc1 L_fin
    s_cmp_ge_u32 s7, 8
    s_cbranch_scc1 L_fin
    v_mov_b32 v4, 111616
    s_mov_b32 s81, 4000000
Lw_7:
    ds_read_b32 v5, v4
    s_waitcnt lgkmcnt(0)
    v_cmp_eq_u32 vcc, 2, v5
    s_cbranch_vccnz Lwd_8
    s_sleep 1
    s_sub_u32 s81, s81, 1
    s_cbranch_scc0 Lw_7
Lwd_8:
    s_lshr_b32 s12, s7, 2
    s_and_b32 s13, s7, 3
    s_lshl_b32 s13, s13, 5
    s_lshl_b32 s9, s5, 7
    s_add_u32 s13, s13, s9
    s_lshl_b32 s75, s12, 12
    s_lshl_b32 s9, s13, 2
    s_add_u32 s75, s75, s9
    s_mov_b32 s56, s16
    s_mov_b32 s57, s17
    s_mov_b32 s58, 4096
    s_mov_b32 s59, 0x20000
    s_mov_b32 s60, s34
    s_mov_b32 s61, s35
    s_mov_b32 s62, 2048
    s_mov_b32 s63, 0x20000
    v_bfe_u32 v4, v1, 4, 1
    v_lshrrev_b32 v5, 5, v1
    v_lshl_or_b32 v4, v4, 1, v5
    v_and_b32 v8, 7, v1
    v_lshl_add_u32 v11, v8, 2, v4
    v_lshlrev_b32 v5, 1, v11
    s_lshr_b32 s9, s75, 1
    buffer_load_ushort v48, v5, s[56:59], s9 offen
    s_lshl_b32 s9, s13, 1
    buffer_load_ushort v49, v5, s[60:63], s9 offen
    v_lshlrev_b32 v10, 15, v7
    v_lshl_add_u32 v10, v8, 4, v10
    s_lshl_b32 s14, s12, 14
    s_lshl_b32 s9, s13, 2
    s_add_u32 s14, s14, s9
    s_mov_b32 s81, 200007
Lpoll_9:
    s_add_u32 s9, s14, 1310720
    buffer_load_dwordx4 v[32:35], v10, s[52:55], s9 offen sc1
    s_add_u32 s9, s14, 1314816
    buffer_load_dwordx4 v[36:39], v10, s[52:55], s9 offen sc1
    s_add_u32 s9, s14, 1318912
    buffer_load_dwordx4 v[40:43], v10, s[52:55], s9 offen sc1
    s_add_u32 s9, s14, 1323008
    buffer_load_dwordx4 v[44:47], v10, s[52:55], s9 offen sc1
Lchk_11:
    s_waitcnt vmcnt(0)
    v_xor_b32 v32, v13, v32
    v_xor_b32 v33, v13, v33
    v_xor_b32 v34, v13, v34
    v_xor_b32 v35, v13, v35
    v_xor_b32 v36, v13, v36
    v_xor_b32 v37, v13, v37
    v_xor_b32 v38, v13, v38
    v_xor_b32 v39, v13, v39
    v_xor_b32 v40, v13, v40
    v_xor_b32 v41, v13, v41
    v_xor_b32 v42, v13, v42
    v_xor_b32 v43, v13, v43
    v_xor_b32 v44, v13, v44
    v_xor_b32 v45, v13, v45
    v_xor_b32 v46, v13, v46
    v_xor_b32 v47, v13, v47
    v_or_b32 v12, v32, v33
    v_or3_b32 v12, v12, v34, v35
    v_or3_b32 v12, v12, v36, v37
    v_or3_b32 v12, v12, v38, v39
    v_or3_b32 v12, v12, v40, v41
    v_or3_b32 v12, v12, v42, v43
    v_or3_b32 v12, v12, v44, v45
    v_or3_b32 v12, v12, v46, v47
    v_and_b32 v12, s83, v12
    v_cmp_ne_u32 vcc, 0, v12
    s_cbranch_vccz Ldone_10
    s_mov_b64 exec, vcc
    s_sleep 16
    s_sub_u32 s81, s81, 1
    s_cbranch_scc0 Lpoll_9
Ldone_10:
    s_mov_b64 exec, -1
    v_permlane32_swap_b32 v32, v33
    v_permlane32_swap_b32 v34, v35
    v_add_f32 v32, v32, v33
    v_add_f32 v34, v34, v35
    s_nop 1
    v_permlane16_swap_b32 v32, v34
    v_add_f32 v32, v32, v34
    s_nop 1
    v_add_f32_dpp v32, v32, v32 row_ror:8 row_mask:0xf bank_mask:0xf
    v_permlane32_swap_b32 v36, v37
    v_permlane32_swap_b32 v38, v39
    v_add_f32 v36, v36, v37
    v_add_f32 v38, v38, v39
    s_nop 1
    v_permlane16_swap_b32 v36, v38
    v_add_f32 v36, v36, v38
    s_nop 1
    v_add_f32_dpp v36, v36, v36 row_ror:8 row_mask:0xf bank_mask:0xf
    v_permlane32_swap_b32 v40, v41
    v_permlane32_swap_b32 v42, v43
    v_add_f32 v40, v40, v41
    v_add_f32 v42, v42, v43
    s_nop 1
    v_permlane16_swap_b32 v40, v42
    v_add_f32 v40, v40, v42
    s_nop 1
    v_add_f32_dpp v40, v40, v40 row_ror:8 row_mask:0xf bank_mask:0xf
    v_permlane32_swap_b32 v44, v45
    v_permlane32_swap_b32 v46, v47
    v_add_f32 v44, v44, v45
    v_add_f32 v46, v46, v47
    s_nop 1
    v_permlane16_swap_b32 v44, v46
    v_add_f32 v44, v44, v46
    s_nop 1
    v_add_f32_dpp v44, v44, v44 row_ror:8 row_mask:0xf bank_mask:0xf
    v_cvt_pk_bf16_f32 v5, v32, v44
    v_lshlrev_b32 v32, 16, v5
    v_and_b32 v44, s78, v5
    v_cvt_pk_bf16_f32 v5, v36, v40
    v_lshlrev_b32 v36, 16, v5
    v_and_b32 v40, s78, v5
    v_add_f32 v40, 1.0, v40
    v_cvt_pk_bf16_f32 v40, v40, v40
    v_lshlrev_b32 v40, 16, v40
    v_or_b32 v36, v13, v36
    v_or_b32 v40, v13, v40
    v_lshlrev_b32 v9, 2, v11
    s_add_u32 s9, s75, 45056
    s_add_u32 s10, s75, 53248
    v_mov_b32 v60, v36
    v_mov_b32 v64, v40
    v_mov_b32 v61, v60
    s_nop 1
    v_permlane32_swap_b32 v60, v61
    v_mov_b32 v62, v60
    v_mov_b32 v63, v61
    s_nop 0
    v_permlane16_swap_b32 v60, v62
    v_permlane16_swap_b32 v61, v63
    v_mov_b32 v65, v64
    s_nop 1
    v_permlane32_swap_b32 v64, v65
    v_mov_b32 v66, v64
    v_mov_b32 v67, v65
    s_nop 0
    v_permlane16_swap_b32 v64, v66
    v_permlane16_swap_b32 v65, v67
    v_lshlrev_b32 v68, 4, v1
    s_mov_b64 exec, 0xff
    buffer_store_dwordx4 v[60:63], v68, s[52:55], s9 offen sc1
    buffer_store_dwordx4 v[64:67], v68, s[52:55], s10 offen sc1
    s_mov_b64 exec, -1
    v_lshlrev_b32 v48, 16, v48
    v_lshlrev_b32 v49, 16, v49
    v_add_u32 v5, 111744, v9
    ds_write_b32 v5, v44 offset:128
    ds_write_b32 v5, v49 offset:256
    ds_write_b32 v5, v32 offset:384
    ds_write_b32 v5, v48 offset:512
    v_xor_b32 v36, v13, v36
    v_xor_b32 v40, v13, v40
    ds_write_b32 v5, v36
    ds_write_b32 v5, v40 offset:640
    v_lshlrev_b32 v56, 1, v1
    s_add_u32 s10, s75, 565248
    v_mov_b32 v52, v40
    v_mul_f32 v53, v40, v40
    v_mul_f32 v54, v40, v36
    v_mov_b32 v55, 0
    s_mov_b32 exec_lo, 0xff00ff00
    s_mov_b32 exec_hi, 0xff00ff00
    v_mov_b32 v52, v36
    v_mul_f32 v53, v36, v36
    v_mov_b32 v54, 0
    s_mov_b64 exec, -1
    v_permlane32_swap_b32 v52, v53
    v_permlane32_swap_b32 v54, v55
    v_add_f32 v52, v52, v53
    v_add_f32 v54, v54, v55
    s_nop 1
    v_permlane16_swap_b32 v52, v54
    v_add_f32 v52, v52, v54
    s_nop 1
    v_add_f32_dpp v52, v52, v52 quad_perm:[1,0,3,2] row_mask:0xf bank_mask:0xf
    s_nop 1
    v_add_f32_dpp v52, v52, v52 quad_perm:[2,3,0,1] row_mask:0xf bank_mask:0xf
    s_nop 1
    v_add_f32_dpp v52, v52, v52 row_half_mirror row_mask:0xf bank_mask:0xf
    v_mov_b32 v53, v52
    s_nop 1
    v_permlane32_swap_b32 v52, v53
    v_mov_b32 v54, v52
    v_mov_b32 v55, v53
    s_nop 0
    v_permlane16_swap_b32 v52, v54
    v_permlane16_swap_b32 v53, v55
    v_mov_b32 v55, s82
    s_mov_b64 exec, 0x101
    buffer_store_dwordx4 v[52:55], v56, s[52:55], s10 offen sc1
    s_mov_b64 exec, -1
    s_waitcnt lgkmcnt(0)
    s_branch L_fin
L_moda:
    s_setprio 3
    s_lshr_b32 s12, s6, 2
    s_lshl_b32 s13, s12, 7
    s_bfe_u32 s14, s6, 0x10001
    s_and_b32 s15, s6, 1
    s_lshl_b32 s88, s14, 11
    s_lshl_b32 s9, s5, 8
    s_add_u32 s88, s88, s9
    s_lshl_b32 s9, s15, 7
    s_add_u32 s88, s88, s9
    s_mul_i32 s10, s13, 12288
    s_add_u32 s10, s10, s88
    s_mov_b32 s9, 98304
    v_mul_lo_u32 v8, v7, s9
    v_and_b32 v9, 7, v1
    v_lshl_add_u32 v8, v9, 4, v8
    v_bfe_u32 v10, v1, 2, 1
    v_lshlrev_b32 v10, 11, v10
    v_lshl_add_u32 v10, v7, 4, v10
    s_lshl_b32 s11, s13, 1
    s_waitcnt lgkmcnt(0)
    s_mov_b32 s56, s38
    s_mov_b32 s57, s39
    s_mov_b32 s58, 12582912
    s_mov_b32 s59, 0x20000
    s_mov_b32 s60, s36
    s_mov_b32 s61, s37
    s_mov_b32 s62, 4096
    s_mov_b32 s63, 0x20000
    buffer_load_dwordx4 v[32:35], v10, s[60:63], s11 offen offset:0
    buffer_load_dwordx4 v[36:39], v10, s[60:63], s11 offen offset:128
    s_add_u32 s9, s10, 0
    buffer_load_dwordx4 v[72:75], v8, s[56:59], s9 offen nt
    s_add_u32 s9, s10, 12288
    buffer_load_dwordx4 v[76:79], v8, s[56:59], s9 offen nt
    s_add_u32 s9, s10, 24576
    buffer_load_dwordx4 v[80:83], v8, s[56:59], s9 offen nt
    s_add_u32 s9, s10, 36864
    buffer_load_dwordx4 v[84:87], v8, s[56:59], s9 offen nt
    s_add_u32 s9, s10, 49152
    buffer_load_dwordx4 v[88:91], v8, s[56:59], s9 offen nt
    s_add_u32 s9, s10, 61440
    buffer_load_dwordx4 v[92:95], v8, s[56:59], s9 offen nt
    s_add_u32 s9, s10, 73728
    buffer_load_dwordx4 v[96:99], v8, s[56:59], s9 offen nt
    s_add_u32 s9, s10, 86016
    buffer_load_dwordx4 v[100:103], v8, s[56:59], s9 offen nt
    s_add_u32 s9, s10, 786432
    buffer_load_dwordx4 v[104:107], v8, s[56:59], s9 offen nt
    s_add_u32 s9, s10, 798720
    buffer_load_dwordx4 v[108:111], v8, s[56:59], s9 offen nt
    s_add_u32 s9, s10, 811008
    buffer_load_dwordx4 v[112:115], v8, s[56:59], s9 offen nt
    s_add_u32 s9, s10, 823296
    buffer_load_dwordx4 v[116:119], v8, s[56:59], s9 offen nt
    s_add_u32 s9, s10, 835584
    buffer_load_dwordx4 v[120:123], v8, s[56:59], s9 offen nt
    s_add_u32 s9, s10, 847872
    buffer_load_dwordx4 v[124:127], v8, s[56:59], s9 offen nt
    s_add_u32 s9, s10, 860160
    buffer_load_dwordx4 v[128:131], v8, s[56:59], s9 offen nt
    s_add_u32 s9, s10, 872448
    buffer_load_dwordx4 v[132:135], v8, s[56:59], s9 offen nt
    s_barrier
    s_load_dword s82, s[42:43], 0
    s_mov_b32 s52, s42
    s_mov_b32 s53, s43
    s_mov_b32 s54, 268435456
    s_mov_b32 s55, 0x20000
    s_waitcnt lgkmcnt(0)
    s_add_u32 s82, s82, 1
    s_and_b32 s8, s82, 1023
    v_mov_b32 v13, s8
    s_lshl_b32 s13, s5, 14
    s_lshl_b32 s9, s12, 11
    s_add_u32 s13, s13, s9
    s_lshl_b32 s9, s14, 10
    s_add_u32 s13, s13, s9
    s_lshl_b32 s9, s15, 8
    s_add_u32 s13, s13, s9
    s_add_u32 s13, s13, 720896
    s_waitcnt vmcnt(16)
    s_mov_b32 s9, 0xbfb8aa3b
    v_lshlrev_b32 v4, 16, v32
    v_and_b32 v5, s78, v32
    v_mul_f32 v6, s9, v4
    v_mul_f32 v11, s9, v5
    v_exp_f32 v6, v6
    v_exp_f32 v11, v11
    v_add_f32 v6, 1.0, v6
    v_add_f32 v11, 1.0, v11
    v_rcp_f32 v6, v6
    v_rcp_f32 v11, v11
    v_mul_f32 v4, v4, v6
    v_mul_f32 v5, v5, v11
    v_cvt_pk_bf16_f32 v16, v4, v5
    v_lshlrev_b32 v4, 16, v33
    v_and_b32 v5, s78, v33
    v_mul_f32 v6, s9, v4
    v_mul_f32 v11, s9, v5
    v_exp_f32 v6, v6
    v_exp_f32 v11, v11
    v_add_f32 v6, 1.0, v6
    v_add_f32 v11, 1.0, v11
    v_rcp_f32 v6, v6
    v_rcp_f32 v11, v11
    v_mul_f32 v4, v4, v6
    v_mul_f32 v5, v5, v11
    v_cvt_pk_bf16_f32 v17, v4, v5
    v_lshlrev_b32 v4, 16, v34
    v_and_b32 v5, s78, v34
    v_mul_f32 v6, s9, v4
    v_mul_f32 v11, s9, v5
    v_exp_f32 v6, v6
    v_exp_f32 v11, v11
    v_add_f32 v6, 1.0, v6
    v_add_f32 v11, 1.0, v11
    v_rcp_f32 v6, v6
    v_rcp_f32 v11, v11
    v_mul_f32 v4, v4, v6
    v_mul_f32 v5, v5, v11
    v_cvt_pk_bf16_f32 v18, v4, v5
    v_lshlrev_b32 v4, 16, v35
    v_and_b32 v5, s78, v35
    v_mul_f32 v6, s9, v4
    v_mul_f32 v11, s9, v5
    v_exp_f32 v6, v6
    v_exp_f32 v11, v11
    v_add_f32 v6, 1.0, v6
    v_add_f32 v11, 1.0, v11
    v_rcp_f32 v6, v6
    v_rcp_f32 v11, v11
    v_mul_f32 v4, v4, v6
    v_mul_f32 v5, v5, v11
    v_cvt_pk_bf16_f32 v19, v4, v5
    v_lshlrev_b32 v4, 16, v36
    v_and_b32 v5, s78, v36
    v_mul_f32 v6, s9, v4
    v_mul_f32 v11, s9, v5
    v_exp_f32 v6, v6
    v_exp_f32 v11, v11
    v_add_f32 v6, 1.0, v6
    v_add_f32 v11, 1.0, v11
    v_rcp_f32 v6, v6
    v_rcp_f32 v11, v11
    v_mul_f32 v4, v4, v6
    v_mul_f32 v5, v5, v11
    v_cvt_pk_bf16_f32 v20, v4, v5
    v_lshlrev_b32 v4, 16, v37
    v_and_b32 v5, s78, v37
    v_mul_f32 v6, s9, v4
    v_mul_f32 v11, s9, v5
    v_exp_f32 v6, v6
    v_exp_f32 v11, v11
    v_add_f32 v6, 1.0, v6
    v_add_f32 v11, 1.0, v11
    v_rcp_f32 v6, v6
    v_rcp_f32 v11, v11
    v_mul_f32 v4, v4, v6
    v_mul_f32 v5, v5, v11
    v_cvt_pk_bf16_f32 v21, v4, v5
    v_lshlrev_b32 v4, 16, v38
    v_and_b32 v5, s78, v38
    v_mul_f32 v6, s9, v4
    v_mul_f32 v11, s9, v5
    v_exp_f32 v6, v6
    v_exp_f32 v11, v11
    v_add_f32 v6, 1.0, v6
    v_add_f32 v11, 1.0, v11
    v_rcp_f32 v6, v6
    v_rcp_f32 v11, v11
    v_mul_f32 v4, v4, v6
    v_mul_f32 v5, v5, v11
    v_cvt_pk_bf16_f32 v22, v4, v5
    v_lshlrev_b32 v4, 16, v39
    v_and_b32 v5, s78, v39
    v_mul_f32 v6, s9, v4
    v_mul_f32 v11, s9, v5
    v_exp_f32 v6, v6
    v_exp_f32 v11, v11
    v_add_f32 v6, 1.0, v6
    v_add_f32 v11, 1.0, v11
    v_rcp_f32 v6, v6
    v_rcp_f32 v11, v11
    v_mul_f32 v4, v4, v6
    v_mul_f32 v5, v5, v11
    v_cvt_pk_bf16_f32 v23, v4, v5
    v_and_b32 v11, 3, v1
    v_bfe_u32 v10, v1, 4, 1
    v_lshl_add_u32 v9, v10, 2, v11
    v_lshrrev_b32 v10, 5, v1
    v_lshl_add_u32 v9, v9, 1, v10
    v_bfe_u32 v10, v1, 2, 1
    s_waitcnt vmcnt(8)
    v_perm_b32 v64, v76, v72, s76
    v_perm_b32 v65, v84, v80, s76
    v_perm_b32 v66, v92, v88, s76
    v_perm_b32 v67, v100, v96, s76
    s_nop 1
    v_mfma_f32_16x16x32_bf16 v[32:35], v[64:67], v[16:19], 0
    v_perm_b32 v68, v76, v72, s77
    v_perm_b32 v69, v84, v80, s77
    v_perm_b32 v70, v92, v88, s77
    v_perm_b32 v71, v100, v96, s77
    s_nop 1
    v_mfma_f32_16x16x32_bf16 v[36:39], v[68:71], v[16:19], 0
    v_perm_b32 v64, v77, v73, s76
    v_perm_b32 v65, v85, v81, s76
    v_perm_b32 v66, v93, v89, s76
    v_perm_b32 v67, v101, v97, s76
    s_nop 1
    v_mfma_f32_16x16x32_bf16 v[40:43], v[64:67], v[16:19], 0
    v_perm_b32 v68, v77, v73, s77
    v_perm_b32 v69, v85, v81, s77
    v_perm_b32 v70, v93, v89, s77
    v_perm_b32 v71, v101, v97, s77
    s_nop 1
    v_mfma_f32_16x16x32_bf16 v[44:47], v[68:71], v[16:19], 0
    v_perm_b32 v64, v78, v74, s76
    v_perm_b32 v65, v86, v82, s76
    v_perm_b32 v66, v94, v90, s76
    v_perm_b32 v67, v102, v98, s76
    s_nop 1
    v_mfma_f32_16x16x32_bf16 v[48:51], v[64:67], v[16:19], 0
    v_perm_b32 v68, v78, v74, s77
    v_perm_b32 v69, v86, v82, s77
    v_perm_b32 v70, v94, v90, s77
    v_perm_b32 v71, v102, v98, s77
    s_nop 1
    v_mfma_f32_16x16x32_bf16 v[52:55], v[68:71], v[16:19], 0
    v_perm_b32 v64, v79, v75, s76
    v_perm_b32 v65, v87, v83, s76
    v_perm_b32 v66, v95, v91, s76
    v_perm_b32 v67, v103, v99, s76
    s_nop 1
    v_mfma_f32_16x16x32_bf16 v[56:59], v[64:67], v[16:19], 0
    v_perm_b32 v68, v79, v75, s77
    v_perm_b32 v69, v87, v83, s77
    v_perm_b32 v70, v95, v91, s77
    v_perm_b32 v71, v103, v99, s77
    s_nop 1
    v_mfma_f32_16x16x32_bf16 v[60:63], v[68:71], v[16:19], 0
    s_waitcnt vmcnt(0)
    v_perm_b32 v64, v108, v104, s76
    v_perm_b32 v65, v116, v112, s76
    v_perm_b32 v66, v124, v120, s76
    v_perm_b32 v67, v132, v128, s76
    s_nop 1
    v_mfma_f32_16x16x32_bf16 v[32:35], v[64:67], v[20:23], v[32:35]
    v_perm_b32 v68, v108, v104, s77
    v_perm_b32 v69, v116, v112, s77
    v_perm_b32 v70, v124, v120, s77
    v_perm_b32 v71, v132, v128, s77
    s_nop 1
    v_mfma_f32_16x16x32_bf16 v[36:39], v[68:71], v[20:23], v[36:39]
    v_perm_b32 v64, v109, v105, s76
    v_perm_b32 v65, v117, v113, s76
    v_perm_b32 v66, v125, v121, s76
    v_perm_b32 v67, v133, v129, s76
    s_nop 1
    v_mfma_f32_16x16x32_bf16 v[40:43], v[64:67], v[20:23], v[40:43]
    v_perm_b32 v68, v109, v105, s77
    v_perm_b32 v69, v117, v113, s77
    v_perm_b32 v70, v125, v121, s77
    v_perm_b32 v71, v133, v129, s77
    s_nop 1
    v_mfma_f32_16x16x32_bf16 v[44:47], v[68:71], v[20:23], v[44:47]
    v_perm_b32 v64, v110, v106, s76
    v_perm_b32 v65, v118, v114, s76
    v_perm_b32 v66, v126, v122, s76
    v_perm_b32 v67, v134, v130, s76
    s_nop 1
    v_mfma_f32_16x16x32_bf16 v[48:51], v[64:67], v[20:23], v[48:51]
    v_perm_b32 v68, v110, v106, s77
    v_perm_b32 v69, v118, v114, s77
    v_perm_b32 v70, v126, v122, s77
    v_perm_b32 v71, v134, v130, s77
    s_nop 1
    v_mfma_f32_16x16x32_bf16 v[52:55], v[68:71], v[20:23], v[52:55]
    v_perm_b32 v64, v111, v107, s76
    v_perm_b32 v65, v119, v115, s76
    v_perm_b32 v66, v127, v123, s76
    v_perm_b32 v67, v135, v131, s76
    s_nop 1
    v_mfma_f32_16x16x32_bf16 v[56:59], v[64:67], v[20:23], v[56:59]
    v_perm_b32 v68, v111, v107, s77
    v_perm_b32 v69, v119, v115, s77
    v_perm_b32 v70, v127, v123, s77
    v_perm_b32 v71, v135, v131, s77
    s_nop 1
    v_mfma_f32_16x16x32_bf16 v[60:63], v[68:71], v[20:23], v[60:63]
    v_permlane32_swap_b32 v32, v48
    v_permlane32_swap_b32 v33, v49
    v_permlane32_swap_b32 v34, v50
    v_permlane32_swap_b32 v35, v51
    v_permlane32_swap_b32 v36, v52
    v_permlane32_swap_b32 v37, v53
    v_permlane32_swap_b32 v38, v54
    v_permlane32_swap_b32 v39, v55
    v_permlane32_swap_b32 v40, v56
    v_permlane32_swap_b32 v41, v57
    v_permlane32_swap_b32 v42, v58
    v_permlane32_swap_b32 v43, v59
    v_permlane32_swap_b32 v44, v60
    v_permlane32_swap_b32 v45, v61
    v_permlane32_swap_b32 v46, v62
    v_permlane32_swap_b32 v47, v63
    v_add_f32_dpp v72, v48, v32 row_ror:8 row_mask:0xf bank_mask:0xf
    v_add_f32_dpp v76, v49, v33 row_ror:8 row_mask:0xf bank_mask:0xf
    v_add_f32_dpp v80, v50, v34 row_ror:8 row_mask:0xf bank_mask:0xf
    v_add_f32_dpp v84, v51, v35 row_ror:8 row_mask:0xf bank_mask:0xf
    v_add_f32_dpp v73, v52, v36 row_ror:8 row_mask:0xf bank_mask:0xf
    v_add_f32_dpp v77, v53, v37 row_ror:8 row_mask:0xf bank_mask:0xf
    v_add_f32_dpp v81, v54, v38 row_ror:8 row_mask:0xf bank_mask:0xf
    v_add_f32_dpp v85, v55, v39 row_ror:8 row_mask:0xf bank_mask:0xf
    v_add_f32_dpp v74, v56, v40 row_ror:8 row_mask:0xf bank_mask:0xf
    v_add_f32_dpp v78, v57, v41 row_ror:8 row_mask:0xf bank_mask:0xf
    v_add_f32_dpp v82, v58, v42 row_ror:8 row_mask:0xf bank_mask:0xf
    v_add_f32_dpp v86, v59, v43 row_ror:8 row_mask:0xf bank_mask:0xf
    v_add_f32_dpp v75, v60, v44 row_ror:8 row_mask:0xf bank_mask:0xf
    v_add_f32_dpp v79, v61, v45 row_ror:8 row_mask:0xf bank_mask:0xf
    v_add_f32_dpp v83, v62, v46 row_ror:8 row_mask:0xf bank_mask:0xf
    v_add_f32_dpp v87, v63, v47 row_ror:8 row_mask:0xf bank_mask:0xf
    v_cmp_eq_u32 vcc, 1, v11
    s_nop 1
    v_cndmask_b32 v72, v72, v76, vcc
    v_cndmask_b32 v73, v73, v77, vcc
    v_cndmask_b32 v74, v74, v78, vcc
    v_cndmask_b32 v75, v75, v79, vcc
    v_cmp_eq_u32 vcc, 2, v11
    s_nop 1
    v_cndmask_b32 v72, v72, v80, vcc
    v_cndmask_b32 v73, v73, v81, vcc
    v_cndmask_b32 v74, v74, v82, vcc
    v_cndmask_b32 v75, v75, v83, vcc
    v_cmp_eq_u32 vcc, 3, v11
    s_nop 1
    v_cndmask_b32 v72, v72, v84, vcc
    v_cndmask_b32 v73, v73, v85, vcc
    v_cndmask_b32 v74, v74, v86, vcc
    v_cndmask_b32 v75, v75, v87, vcc
    v_add_u32 v72, 2, v72
    v_bfi_b32 v72, 3, v13, v72
    v_add_u32 v73, 2, v73
    v_bfi_b32 v73, 3, v13, v73
    v_add_u32 v74, 2, v74
    v_bfi_b32 v74, 3, v13, v74
    v_add_u32 v75, 2, v75
    v_bfi_b32 v75, 3, v13, v75
    v_lshlrev_b32 v9, 4, v9
    v_lshl_add_u32 v9, v10, 9, v9
    s_mov_b32 exec_lo, 0x00ff00ff
    s_mov_b32 exec_hi, 0x00ff00ff
    buffer_store_dwordx4 v[72:75], v9, s[52:55], s13 offen
    s_mov_b64 exec, -1
    v_mov_b32 v4, 111628
    v_mov_b32 v5, 1
    ds_write_b32 v4, v5
    s_getreg_b32 s88, hwreg(HW_REG_XCC_ID)
    s_lshl_b32 s88, s88, 12
    s_waitcnt vmcnt(0)
    v_and_b32 v8, 31, v1
    v_lshlrev_b32 v8, 7, v8
    s_lshl_b32 s10, s5, 12
    s_add_u32 s10, s10, 491520
    s_mov_b32 s81, 200007
Lpoll_12:
    buffer_load_dwordx4 v[32:35], v8, s[52:55], s10 offen sc1
Lchk_14:
    s_waitcnt vmcnt(0)
    v_xor_b32 v32, v13, v32
    v_xor_b32 v33, v13, v33
    v_xor_b32 v34, v13, v34
    v_xor_b32 v35, v13, v35
    v_or_b32 v12, v32, v33
    v_or3_b32 v12, v12, v34, v35
    v_and_b32 v12, s83, v12
    v_cmp_ne_u32 vcc, 0, v12
    s_cbranch_vccz Ldone_13
    s_mov_b64 exec, vcc
    s_sub_u32 s81, s81, 1
    s_cbranch_scc0 Lpoll_12
Ldone_13:
    s_mov_b64 exec, -1
    v_cmp_ne_u32 vcc, s88, v32
    s_nop 0
    s_cmp_eq_u64 vcc, 0
    s_cselect_b32 s101, 1, 2
    v_mov_b32 v4, 111624
    v_mov_b32 v5, s101
    ds_write_b32 v4, v5
    s_cmp_eq_u32 s101, 1
    s_cbranch_scc1 L_maok
    s_mov_b32 exec_lo, 0x00ff00ff
    s_mov_b32 exec_hi, 0x00ff00ff
    buffer_store_dwordx4 v[72:75], v9, s[52:55], s13 offen sc1
    s_mov_b64 exec, -1
L_maok:
    v_lshlrev_b32 v9, 4, v1
    s_lshl_b32 s10, s5, 12
    s_add_u32 s10, s10, 524288
    v_mov_b32 v4, 111620
    s_mov_b32 s81, 4000000
Lw_15:
    ds_read_b32 v5, v4
    s_waitcnt lgkmcnt(0)
    v_cmp_eq_u32 vcc, 3, v5
    s_cbranch_vccnz Lwd_16
    s_sleep 1
    s_sub_u32 s81, s81, 1
    s_cbranch_scc0 Lw_15
Lwd_16:
    s_mov_b32 s81, 200007
Lpoll_17:
    buffer_load_dwordx4 v[32:35], v9, s[52:55], s10 offen offset:0 sc1
    buffer_load_dwordx4 v[36:39], v9, s[52:55], s10 offen offset:1024 sc1
    buffer_load_dwordx4 v[40:43], v9, s[52:55], s10 offen offset:2048 sc1
    buffer_load_dwordx4 v[44:47], v9, s[52:55], s10 offen offset:3072 sc1
Lchk_19:
    s_waitcnt vmcnt(0)
    v_xor_b32 v32, v13, v32
    v_xor_b32 v33, v13, v33
    v_xor_b32 v34, v13, v34
    v_xor_b32 v35, v13, v35
    v_xor_b32 v36, v13, v36
    v_xor_b32 v37, v13, v37
    v_xor_b32 v38, v13, v38
    v_xor_b32 v39, v13, v39
    v_xor_b32 v40, v13, v40
    v_xor_b32 v41, v13, v41
    v_xor_b32 v42, v13, v42
    v_xor_b32 v43, v13, v43
    v_xor_b32 v44, v13, v44
    v_xor_b32 v45, v13, v45
    v_xor_b32 v46, v13, v46
    v_xor_b32 v47, v13, v47
    v_or_b32 v12, v32, v33
    v_or3_b32 v12, v12, v34, v35
    v_or3_b32 v12, v12, v36, v37
    v_or3_b32 v12, v12, v38, v39
    v_or3_b32 v12, v12, v40, v41
    v_or3_b32 v12, v12, v42, v43
    v_or3_b32 v12, v12, v44, v45
    v_or3_b32 v12, v12, v46, v47
    v_and_b32 v12, s83, v12
    v_cmp_ne_u32 vcc, 0, v12
    s_cbranch_vccz Ldone_18
    s_mov_b64 exec, vcc
    s_sub_u32 s81, s81, 1
    s_cbranch_scc0 Lpoll_17
Ldone_18:
    s_mov_b64 exec, -1
    v_perm_b32 v48, v33, v32, s77
    v_perm_b32 v49, v35, v34, s77
    v_perm_b32 v50, v37, v36, s77
    v_perm_b32 v51, v39, v38, s77
    v_perm_b32 v52, v41, v40, s77
    v_perm_b32 v53, v43, v42, s77
    v_perm_b32 v54, v45, v44, s77
    v_perm_b32 v55, v47, v46, s77
    v_and_b32 v9, 7, v1
    v_lshlrev_b32 v9, 5, v9
    v_bfe_u32 v10, v1, 3, 2
    v_lshl_add_u32 v9, v10, 3, v9
    v_lshrrev_b32 v10, 5, v1
    v_lshl_add_u32 v9, v10, 8, v9
    v_add_u32 v9, 99328, v9
    ds_write_b64 v9, v[48:49] offset:0
    ds_write_b64 v9, v[50:51] offset:512
    ds_write_b64 v9, v[52:53] offset:1024
    ds_write_b64 v9, v[54:55] offset:1536
    v_mov_b32 v4, 111616
    v_mov_b32 v5, 2
    s_waitcnt lgkmcnt(0)
    ds_write_b32 v4, v5
    s_waitcnt lgkmcnt(0)
    s_branch L_fin
L_red:
    s_waitcnt lgkmcnt(0)
    s_mov_b32 s52, s42
    s_mov_b32 s53, s43
    s_mov_b32 s54, 268435456
    s_mov_b32 s55, 0x20000
    s_load_dword s82, s[42:43], 0
    s_barrier
    s_setprio 3
    s_mov_b32 s60, s16
    s_mov_b32 s61, s17
    s_mov_b32 s62, 4096
    s_mov_b32 s63, 0x20000
    v_lshrrev_b32 v10, 5, v1
    v_and_b32 v11, 31, v1
    v_lshlrev_b32 v9, 11, v10
    v_lshl_add_u32 v9, v11, 4, v9
    buffer_load_dwordx4 v[72:75], v9, s[60:63], 0 offen offset:0
    buffer_load_dwordx4 v[76:79], v9, s[60:63], 0 offen offset:512
    buffer_load_dwordx4 v[80:83], v9, s[60:63], 0 offen offset:1024
    buffer_load_dwordx4 v[84:87], v9, s[60:63], 0 offen offset:1536
    v_lshlrev_b32 v9, 11, v10
    v_lshl_add_u32 v9, v11, 3, v9
    s_lshl_b32 s11, s5, 8
    buffer_load_dwordx2 v[88:89], v9, s[60:63], s11 offen
    s_getreg_b32 s88, hwreg(HW_REG_XCC_ID)
    s_lshl_b32 s88, s88, 12
    v_lshlrev_b32 v4, 4, v1
    s_lshl_b32 s9, s4, 7
    s_add_u32 s9, s9, 491520
    s_waitcnt lgkmcnt(0)
    s_add_u32 s82, s82, 1
    s_and_b32 s8, s82, 1023
    v_mov_b32 v13, s8
    v_or_b32 v96, s88, v13
    v_mov_b32 v97, v96
    v_mov_b32 v98, v96
    v_mov_b32 v99, v96
    s_mov_b64 exec, 0xff
    buffer_store_dwordx4 v[96:99], v4, s[52:55], s9 offen sc1
    s_mov_b64 exec, -1
    s_add_u32 s9, s9, 32768
    s_lshl_b32 s9, s5, 14
    s_lshl_b32 s10, s7, 10
    s_add_u32 s9, s9, s10
    s_and_b32 s10, s6, 1
    s_lshl_b32 s10, s10, 8
    s_add_u32 s9, s9, s10
    v_lshrrev_b32 v101, 1, v1
    v_lshlrev_b32 v101, 2, v101
    v_and_or_b32 v101, v1, 1, v101
    v_lshlrev_b32 v101, 7, v101
    s_add_u32 s9, s9, 720896
    s_mov_b64 exec, 0xf
    buffer_load_dword v100, v101, s[52:55], s9 offen
    s_mov_b64 exec, -1
    s_lshl_b32 s9, s5, 15
    s_lshl_b32 s10, s6, 9
    s_add_u32 s9, s9, s10
    v_lshrrev_b32 v101, 2, v1
    v_lshlrev_b32 v101, 7, v101
    v_and_or_b32 v101, v1, 3, v101
    v_lshlrev_b32 v101, 7, v101
    s_add_u32 s9, s9, 196608
    s_mov_b64 exec, 0xff
    buffer_load_dword v100, v101, s[52:55], s9 offen
    s_mov_b64 exec, -1
    s_mul_i32 s9, s4, 128
    v_lshrrev_b32 v101, 0, v1
    v_lshlrev_b32 v101, 0, v101
    v_and_or_b32 v101, v1, 0, v101
    v_lshlrev_b32 v101, 7, v101
    s_add_u32 s9, s9, 524288
    s_mov_b64 exec, 0x1
    buffer_load_dword v100, v101, s[52:55], s9 offen
    s_mov_b64 exec, -1
    s_mul_i32 s9, s4, 128
    v_lshrrev_b32 v101, 0, v1
    v_lshlrev_b32 v101, 0, v101
    v_and_or_b32 v101, v1, 0, v101
    v_lshlrev_b32 v101, 7, v101
    s_add_u32 s9, s9, 5242880
    s_mov_b64 exec, 0x1
    buffer_load_dword v100, v101, s[52:55], s9 offen
    s_mov_b64 exec, -1
    s_mul_i32 s9, s4, 128
    v_lshrrev_b32 v101, 0, v1
    v_lshlrev_b32 v101, 0, v101
    v_and_or_b32 v101, v1, 0, v101
    v_lshlrev_b32 v101, 7, v101
    s_add_u32 s9, s9, 4096
    s_mov_b64 exec, 0x1
    buffer_load_dword v100, v101, s[52:55], s9 offen
    s_mov_b64 exec, -1
    s_and_b32 s9, s6, 7
    s_lshl_b32 s9, s9, 15
    s_lshr_b32 s10, s6, 3
    s_lshl_b32 s10, s10, 12
    s_add_u32 s9, s9, s10
    s_lshl_b32 s10, s5, 9
    s_add_u32 s9, s9, s10
    v_lshrrev_b32 v101, 2, v1
    v_lshlrev_b32 v101, 7, v101
    v_and_or_b32 v101, v1, 3, v101
    v_lshlrev_b32 v101, 7, v101
    s_add_u32 s9, s9, 1310720
    s_mov_b64 exec, 0xff
    buffer_load_dword v100, v101, s[52:55], s9 offen
    s_mov_b64 exec, -1
    s_lshl_b32 s9, s5, 17
    s_lshl_b32 s10, s6, 9
    s_add_u32 s9, s9, s10
    v_lshrrev_b32 v101, 2, v1
    v_lshlrev_b32 v101, 7, v101
    v_and_or_b32 v101, v1, 3, v101
    v_lshlrev_b32 v101, 7, v101
    s_add_u32 s9, s9, 2097152
    s_mov_b32 exec_hi, 0
    buffer_load_dword v100, v101, s[52:55], s9 offen
    s_mov_b64 exec, -1
    s_bitcmp1_b32 s6, 0
    s_cbranch_scc1 L_tB
    s_lshl_b32 s9, s7, 13
    s_lshl_b32 s10, s5, 9
    s_add_u32 s9, s9, s10
    v_lshrrev_b32 v101, 2, v1
    v_lshlrev_b32 v101, 5, v101
    v_and_or_b32 v101, v1, 3, v101
    v_lshlrev_b32 v101, 7, v101
    s_add_u32 s9, s9, 1048576
    s_mov_b64 exec, 0xff
    buffer_load_dword v100, v101, s[52:55], s9 offen
    s_mov_b64 exec, -1
    s_cmp_ge_u32 s86, 112
    s_cbranch_scc1 L_tD
    s_lshl_b32 s9, s86, 13
    v_lshrrev_b32 v101, 6, v1
    v_lshlrev_b32 v101, 6, v101
    v_and_or_b32 v101, v1, 63, v101
    v_lshlrev_b32 v101, 7, v101
    s_add_u32 s9, s9, 3145728
    buffer_load_dword v100, v101, s[52:55], s9 offen
    s_cmp_ge_u32 s7, 8
    s_cbranch_scc1 L_tD
    s_lshr_b32 s12, s7, 2
    s_and_b32 s13, s7, 3
    s_lshl_b32 s13, s13, 5
    s_lshl_b32 s9, s5, 7
    s_add_u32 s13, s13, s9
    s_lshl_b32 s75, s12, 12
    s_lshl_b32 s9, s13, 2
    s_add_u32 s75, s75, s9
    s_mov_b32 s9, s75
    v_lshrrev_b32 v101, 0, v1
    v_lshlrev_b32 v101, 6, v101
    v_and_or_b32 v101, v1, 0, v101
    v_lshlrev_b32 v101, 7, v101
    s_add_u32 s9, s9, 45056
    s_mov_b64 exec, 0x3
    buffer_load_dword v100, v101, s[52:55], s9 offen
    s_mov_b64 exec, -1
    s_mov_b32 s9, s75
    v_lshrrev_b32 v101, 0, v1
    v_lshlrev_b32 v101, 6, v101
    v_and_or_b32 v101, v1, 0, v101
    v_lshlrev_b32 v101, 7, v101
    s_add_u32 s9, s9, 565248
    s_mov_b64 exec, 0x1
    buffer_load_dword v100, v101, s[52:55], s9 offen
    s_mov_b64 exec, -1
    s_mul_i32 s9, s75, 33
    v_lshrrev_b32 v101, 0, v1
    v_lshlrev_b32 v101, 0, v101
    v_and_or_b32 v101, v1, 0, v101
    v_lshlrev_b32 v101, 7, v101
    s_add_u32 s9, s9, 1572864
    s_mov_b64 exec, 0x1
    buffer_load_dword v100, v101, s[52:55], s9 offen
    s_mov_b64 exec, -1
    s_mul_i32 s9, s75, 33
    v_lshrrev_b32 v101, 0, v1
    v_lshlrev_b32 v101, 0, v101
    v_and_or_b32 v101, v1, 0, v101
    v_lshlrev_b32 v101, 7, v101
    s_add_u32 s9, s9, 1574912
    s_mov_b64 exec, 0x1
    buffer_load_dword v100, v101, s[52:55], s9 offen
    s_mov_b64 exec, -1
    s_branch L_tD
L_tB:
    s_cmp_ge_u32 s86, 112
    s_cbranch_scc1 L_tD
    s_lshl_b32 s9, s86, 10
    v_lshrrev_b32 v101, 3, v1
    v_lshlrev_b32 v101, 3, v101
    v_and_or_b32 v101, v1, 7, v101
    v_lshlrev_b32 v101, 7, v101
    s_add_u32 s9, s9, 917504
    s_mov_b64 exec, 0xff
    buffer_load_dword v100, v101, s[52:55], s9 offen
    s_mov_b64 exec, -1
L_tD:
    s_waitcnt vmcnt(8)
    v_mov_b32 v4, 0
    v_mov_b32 v5, 0
    v_lshlrev_b32 v6, 16, v72
    v_and_b32 v8, s78, v72
    v_add_f32 v4, v4, v6
    v_fmac_f32 v5, v6, v6
    v_add_f32 v4, v4, v8
    v_fmac_f32 v5, v8, v8
    v_lshlrev_b32 v6, 16, v73
    v_and_b32 v8, s78, v73
    v_add_f32 v4, v4, v6
    v_fmac_f32 v5, v6, v6
    v_add_f32 v4, v4, v8
    v_fmac_f32 v5, v8, v8
    v_lshlrev_b32 v6, 16, v74
    v_and_b32 v8, s78, v74
    v_add_f32 v4, v4, v6
    v_fmac_f32 v5, v6, v6
    v_add_f32 v4, v4, v8
    v_fmac_f32 v5, v8, v8
    v_lshlrev_b32 v6, 16, v75
    v_and_b32 v8, s78, v75
    v_add_f32 v4, v4, v6
    v_fmac_f32 v5, v6, v6
    v_add_f32 v4, v4, v8
    v_fmac_f32 v5, v8, v8
    v_lshlrev_b32 v6, 16, v76
    v_and_b32 v8, s78, v76
    v_add_f32 v4, v4, v6
    v_fmac_f32 v5, v6, v6
    v_add_f32 v4, v4, v8
    v_fmac_f32 v5, v8, v8
    v_lshlrev_b32 v6, 16, v77
    v_and_b32 v8, s78, v77
    v_add_f32 v4, v4, v6
    v_fmac_f32 v5, v6, v6
    v_add_f32 v4, v4, v8
    v_fmac_f32 v5, v8, v8
    v_lshlrev_b32 v6, 16, v78
    v_and_b32 v8, s78, v78
    v_add_f32 v4, v4, v6
    v_fmac_f32 v5, v6, v6
    v_add_f32 v4, v4, v8
    v_fmac_f32 v5, v8, v8
    v_lshlrev_b32 v6, 16, v79
    v_and_b32 v8, s78, v79
    v_add_f32 v4, v4, v6
    v_fmac_f32 v5, v6, v6
    v_add_f32 v4, v4, v8
    v_fmac_f32 v5, v8, v8
    v_lshlrev_b32 v6, 16, v80
    v_and_b32 v8, s78, v80
    v_add_f32 v4, v4, v6
    v_fmac_f32 v5, v6, v6
    v_add_f32 v4, v4, v8
    v_fmac_f32 v5, v8, v8
    v_lshlrev_b32 v6, 16, v81
    v_and_b32 v8, s78, v81
    v_add_f32 v4, v4, v6
    v_fmac_f32 v5, v6, v6
    v_add_f32 v4, v4, v8
    v_fmac_f32 v5, v8, v8
    v_lshlrev_b32 v6, 16, v82
    v_and_b32 v8, s78, v82
    v_add_f32 v4, v4, v6
    v_fmac_f32 v5, v6, v6
    v_add_f32 v4, v4, v8
    v_fmac_f32 v5, v8, v8
    v_lshlrev_b32 v6, 16, v83
    v_and_b32 v8, s78, v83
    v_add_f32 v4, v4, v6
    v_fmac_f32 v5, v6, v6
    v_add_f32 v4, v4, v8
    v_fmac_f32 v5, v8, v8
    v_lshlrev_b32 v6, 16, v84
    v_and_b32 v8, s78, v84
    v_add_f32 v4, v4, v6
    v_fmac_f32 v5, v6, v6
    v_add_f32 v4, v4, v8
    v_fmac_f32 v5, v8, v8
    v_lshlrev_b32 v6, 16, v85
    v_and_b32 v8, s78, v85
    v_add_f32 v4, v4, v6
    v_fmac_f32 v5, v6, v6
    v_add_f32 v4, v4, v8
    v_fmac_f32 v5, v8, v8
    v_lshlrev_b32 v6, 16, v86
    v_and_b32 v8, s78, v86
    v_add_f32 v4, v4, v6
    v_fmac_f32 v5, v6, v6
    v_add_f32 v4, v4, v8
    v_fmac_f32 v5, v8, v8
    v_lshlrev_b32 v6, 16, v87
    v_and_b32 v8, s78, v87
    v_add_f32 v4, v4, v6
    v_fmac_f32 v5, v6, v6
    v_add_f32 v4, v4, v8
    v_fmac_f32 v5, v8, v8
    s_nop 0
    v_add_f32_dpp v4, v4, v4 row_ror:1 row_mask:0xf bank_mask:0xf
    v_add_f32_dpp v5, v5, v5 row_ror:1 row_mask:0xf bank_mask:0xf
    s_nop 0
    v_add_f32_dpp v4, v4, v4 row_ror:2 row_mask:0xf bank_mask:0xf
    v_add_f32_dpp v5, v5, v5 row_ror:2 row_mask:0xf bank_mask:0xf
    s_nop 0
    v_add_f32_dpp v4, v4, v4 row_ror:4 row_mask:0xf bank_mask:0xf
    v_add_f32_dpp v5, v5, v5 row_ror:4 row_mask:0xf bank_mask:0xf
    s_nop 0
    v_add_f32_dpp v4, v4, v4 row_ror:8 row_mask:0xf bank_mask:0xf
    v_add_f32_dpp v5, v5, v5 row_ror:8 row_mask:0xf bank_mask:0xf
    v_mov_b32 v6, v4
    s_nop 1
    v_permlane16_swap_b32 v4, v6
    v_add_f32 v4, v4, v6
    v_mov_b32 v6, v5
    s_nop 1
    v_permlane16_swap_b32 v5, v6
    v_add_f32 v5, v5, v6
    v_mul_f32 v4, 0x3a800000, v4
    v_mul_f32 v5, 0x3a800000, v5
    v_fma_f32 v5, -v4, v4, v5
    v_max_f32 v5, 0, v5
    v_cvt_pk_bf16_f32 v6, v4, v5
    v_lshlrev_b32 v8, 16, v6
    v_and_b32 v5, s78, v6
    v_add_f32 v5, 0x3727c5ac, v5
    v_cvt_pk_bf16_f32 v5, v5, v5
    v_lshlrev_b32 v5, 16, v5
    v_sqrt_f32 v5, v5
    s_nop 0
    v_cvt_pk_bf16_f32 v5, v5, v5
    v_lshlrev_b32 v5, 16, v5
    v_rcp_f32 v9, v5
    v_lshlrev_b32 v24, 16, v88
    v_and_b32 v25, s78, v88
    v_sub_f32 v24, v24, v8
    v_sub_f32 v25, v25, v8
    v_cvt_pk_bf16_f32 v6, v24, v25
    v_lshlrev_b32 v24, 16, v6
    v_and_b32 v25, s78, v6
    v_mul_f32 v24, v24, v9
    v_mul_f32 v25, v25, v9
    v_cvt_pk_bf16_f32 v6, v24, v25
    v_lshlrev_b32 v24, 16, v6
    v_and_b32 v25, s78, v6
    v_lshlrev_b32 v26, 16, v89
    v_and_b32 v27, s78, v89
    v_sub_f32 v26, v26, v8
    v_sub_f32 v27, v27, v8
    v_cvt_pk_bf16_f32 v6, v26, v27
    v_lshlrev_b32 v26, 16, v6
    v_and_b32 v27, s78, v6
    v_mul_f32 v26, v26, v9
    v_mul_f32 v27, v27, v9
    v_cvt_pk_bf16_f32 v6, v26, v27
    v_lshlrev_b32 v26, 16, v6
    v_and_b32 v27, s78, v6
    v_and_b32 v15, 3, v13
    v_lshlrev_b32 v9, 4, v1
    s_lshl_b32 s10, s5, 14
    s_add_u32 s10, s10, 720896
    v_mov_b32 v4, 111628
    s_mov_b32 s81, 4000000
Lw_20:
    ds_read_b32 v5, v4
    s_waitcnt lgkmcnt(0)
    v_cmp_eq_u32 vcc, 1, v5
    s_cbranch_vccnz Lwd_21
    s_sleep 1
    s_sub_u32 s81, s81, 1
    s_cbranch_scc0 Lw_20
Lwd_21:
    s_mov_b32 s81, 200007
Lpoll_22:
    s_add_u32 s9, s10, 0
    buffer_load_dwordx4 v[32:35], v9, s[52:55], s9 offen offset:0 sc1
    buffer_load_dwordx4 v[36:39], v9, s[52:55], s9 offen offset:1024 sc1
    buffer_load_dwordx4 v[40:43], v9, s[52:55], s9 offen offset:2048 sc1
    buffer_load_dwordx4 v[44:47], v9, s[52:55], s9 offen offset:3072 sc1
    s_add_u32 s9, s10, 4096
    buffer_load_dwordx4 v[48:51], v9, s[52:55], s9 offen offset:0 sc1
    buffer_load_dwordx4 v[52:55], v9, s[52:55], s9 offen offset:1024 sc1
    buffer_load_dwordx4 v[56:59], v9, s[52:55], s9 offen offset:2048 sc1
    buffer_load_dwordx4 v[60:63], v9, s[52:55], s9 offen offset:3072 sc1
    s_add_u32 s9, s10, 8192
    buffer_load_dwordx4 v[64:67], v9, s[52:55], s9 offen offset:0 sc1
    buffer_load_dwordx4 v[68:71], v9, s[52:55], s9 offen offset:1024 sc1
    buffer_load_dwordx4 v[72:75], v9, s[52:55], s9 offen offset:2048 sc1
    buffer_load_dwordx4 v[76:79], v9, s[52:55], s9 offen offset:3072 sc1
    s_add_u32 s9, s10, 12288
    buffer_load_dwordx4 v[80:83], v9, s[52:55], s9 offen offset:0 sc1
    buffer_load_dwordx4 v[84:87], v9, s[52:55], s9 offen offset:1024 sc1
    buffer_load_dwordx4 v[88:91], v9, s[52:55], s9 offen offset:2048 sc1
    buffer_load_dwordx4 v[92:95], v9, s[52:55], s9 offen offset:3072 sc1
Lchk_24:
    s_waitcnt vmcnt(0)
    v_xor_b32 v32, v15, v32
    v_xor_b32 v33, v15, v33
    v_xor_b32 v34, v15, v34
    v_xor_b32 v35, v15, v35
    v_xor_b32 v36, v15, v36
    v_xor_b32 v37, v15, v37
    v_xor_b32 v38, v15, v38
    v_xor_b32 v39, v15, v39
    v_xor_b32 v40, v15, v40
    v_xor_b32 v41, v15, v41
    v_xor_b32 v42, v15, v42
    v_xor_b32 v43, v15, v43
    v_xor_b32 v44, v15, v44
    v_xor_b32 v45, v15, v45
    v_xor_b32 v46, v15, v46
    v_xor_b32 v47, v15, v47
    v_xor_b32 v48, v15, v48
    v_xor_b32 v49, v15, v49
    v_xor_b32 v50, v15, v50
    v_xor_b32 v51, v15, v51
    v_xor_b32 v52, v15, v52
    v_xor_b32 v53, v15, v53
    v_xor_b32 v54, v15, v54
    v_xor_b32 v55, v15, v55
    v_xor_b32 v56, v15, v56
    v_xor_b32 v57, v15, v57
    v_xor_b32 v58, v15, v58
    v_xor_b32 v59, v15, v59
    v_xor_b32 v60, v15, v60
    v_xor_b32 v61, v15, v61
    v_xor_b32 v62, v15, v62
    v_xor_b32 v63, v15, v63
    v_xor_b32 v64, v15, v64
    v_xor_b32 v65, v15, v65
    v_xor_b32 v66, v15, v66
    v_xor_b32 v67, v15, v67
    v_xor_b32 v68, v15, v68
    v_xor_b32 v69, v15, v69
    v_xor_b32 v70, v15, v70
    v_xor_b32 v71, v15, v71
    v_xor_b32 v72, v15, v72
    v_xor_b32 v73, v15, v73
    v_xor_b32 v74, v15, v74
    v_xor_b32 v75, v15, v75
    v_xor_b32 v76, v15, v76
    v_xor_b32 v77, v15, v77
    v_xor_b32 v78, v15, v78
    v_xor_b32 v79, v15, v79
    v_xor_b32 v80, v15, v80
    v_xor_b32 v81, v15, v81
    v_xor_b32 v82, v15, v82
    v_xor_b32 v83, v15, v83
    v_xor_b32 v84, v15, v84
    v_xor_b32 v85, v15, v85
    v_xor_b32 v86, v15, v86
    v_xor_b32 v87, v15, v87
    v_xor_b32 v88, v15, v88
    v_xor_b32 v89, v15, v89
    v_xor_b32 v90, v15, v90
    v_xor_b32 v91, v15, v91
    v_xor_b32 v92, v15, v92
    v_xor_b32 v93, v15, v93
    v_xor_b32 v94, v15, v94
    v_xor_b32 v95, v15, v95
    v_or_b32 v12, v32, v33
    v_or3_b32 v12, v12, v34, v35
    v_or3_b32 v12, v12, v36, v37
    v_or3_b32 v12, v12, v38, v39
    v_or3_b32 v12, v12, v40, v41
    v_or3_b32 v12, v12, v42, v43
    v_or3_b32 v12, v12, v44, v45
    v_or3_b32 v12, v12, v46, v47
    v_or3_b32 v12, v12, v48, v49
    v_or3_b32 v12, v12, v50, v51
    v_or3_b32 v12, v12, v52, v53
    v_or3_b32 v12, v12, v54, v55
    v_or3_b32 v12, v12, v56, v57
    v_or3_b32 v12, v12, v58, v59
    v_or3_b32 v12, v12, v60, v61
    v_or3_b32 v12, v12, v62, v63
    v_or3_b32 v12, v12, v64, v65
    v_or3_b32 v12, v12, v66, v67
    v_or3_b32 v12, v12, v68, v69
    v_or3_b32 v12, v12, v70, v71
    v_or3_b32 v12, v12, v72, v73
    v_or3_b32 v12, v12, v74, v75
    v_or3_b32 v12, v12, v76, v77
    v_or3_b32 v12, v12, v78, v79
    v_or3_b32 v12, v12, v80, v81
    v_or3_b32 v12, v12, v82, v83
    v_or3_b32 v12, v12, v84, v85
    v_or3_b32 v12, v12, v86, v87
    v_or3_b32 v12, v12, v88, v89
    v_or3_b32 v12, v12, v90, v91
    v_or3_b32 v12, v12, v92, v93
    v_or3_b32 v12, v12, v94, v95
    v_and_b32 v12, 3, v12
    s_nop 1
    v_or_b32_dpp v12, v12, v12 quad_perm:[1,0,3,2] row_mask:0xf bank_mask:0xf
    s_nop 1
    v_or_b32_dpp v12, v12, v12 quad_perm:[2,3,0,1] row_mask:0xf bank_mask:0xf
    s_nop 1
    v_or_b32_dpp v12, v12, v12 row_half_mirror row_mask:0xf bank_mask:0xf
    v_cmp_ne_u32 vcc, 0, v12
    s_cbranch_vccz Ldone_23
    s_mov_b64 exec, vcc
    s_sub_u32 s81, s81, 1
    s_cbranch_scc0 Lpoll_22
Ldone_23:
    s_mov_b64 exec, -1
    v_add_f32 v32, v32, v64
    v_add_f32 v33, v33, v65
    v_add_f32 v34, v34, v66
    v_add_f32 v35, v35, v67
    v_add_f32 v36, v36, v68
    v_add_f32 v37, v37, v69
    v_add_f32 v38, v38, v70
    v_add_f32 v39, v39, v71
    v_add_f32 v40, v40, v72
    v_add_f32 v41, v41, v73
    v_add_f32 v42, v42, v74
    v_add_f32 v43, v43, v75
    v_add_f32 v44, v44, v76
    v_add_f32 v45, v45, v77
    v_add_f32 v46, v46, v78
    v_add_f32 v47, v47, v79
    v_add_f32 v48, v48, v80
    v_add_f32 v49, v49, v81
    v_add_f32 v50, v50, v82
    v_add_f32 v51, v51, v83
    v_add_f32 v52, v52, v84
    v_add_f32 v53, v53, v85
    v_add_f32 v54, v54, v86
    v_add_f32 v55, v55, v87
    v_add_f32 v56, v56, v88
    v_add_f32 v57, v57, v89
    v_add_f32 v58, v58, v90
    v_add_f32 v59, v59, v91
    v_add_f32 v60, v60, v92
    v_add_f32 v61, v61, v93
    v_add_f32 v62, v62, v94
    v_add_f32 v63, v63, v95
    v_add_f32 v32, v32, v48
    v_add_f32 v33, v33, v49
    v_add_f32 v34, v34, v50
    v_add_f32 v35, v35, v51
    v_add_f32 v36, v36, v52
    v_add_f32 v37, v37, v53
    v_add_f32 v38, v38, v54
    v_add_f32 v39, v39, v55
    v_add_f32 v40, v40, v56
    v_add_f32 v41, v41, v57
    v_add_f32 v42, v42, v58
    v_add_f32 v43, v43, v59
    v_add_f32 v44, v44, v60
    v_add_f32 v45, v45, v61
    v_add_f32 v46, v46, v62
    v_add_f32 v47, v47, v63
    v_add_f32 v32, v32, v40
    v_add_f32 v33, v33, v41
    v_add_f32 v34, v34, v42
    v_add_f32 v35, v35, v43
    v_add_f32 v36, v36, v44
    v_add_f32 v37, v37, v45
    v_add_f32 v38, v38, v46
    v_add_f32 v39, v39, v47
    v_cvt_pk_bf16_f32 v6, v32, v33
    v_lshlrev_b32 v32, 16, v6
    v_and_b32 v33, s78, v6
    v_cvt_pk_bf16_f32 v6, v36, v37
    v_lshlrev_b32 v36, 16, v6
    v_and_b32 v37, s78, v6
    v_add_f32 v36, 1.0, v36
    v_add_f32 v37, 1.0, v37
    v_cvt_pk_bf16_f32 v6, v36, v37
    v_lshlrev_b32 v36, 16, v6
    v_and_b32 v37, s78, v6
    v_mul_f32 v36, v36, v24
    v_mul_f32 v37, v37, v25
    v_cvt_pk_bf16_f32 v6, v36, v37
    v_lshlrev_b32 v36, 16, v6
    v_and_b32 v37, s78, v6
    v_add_f32 v36, v36, v32
    v_add_f32 v37, v37, v33
    v_cvt_pk_bf16_f32 v40, v36, v37
    v_cvt_pk_bf16_f32 v6, v34, v35
    v_lshlrev_b32 v34, 16, v6
    v_and_b32 v35, s78, v6
    v_cvt_pk_bf16_f32 v6, v38, v39
    v_lshlrev_b32 v38, 16, v6
    v_and_b32 v39, s78, v6
    v_add_f32 v38, 1.0, v38
    v_add_f32 v39, 1.0, v39
    v_cvt_pk_bf16_f32 v6, v38, v39
    v_lshlrev_b32 v38, 16, v6
    v_and_b32 v39, s78, v6
    v_mul_f32 v38, v38, v26
    v_mul_f32 v39, v39, v27
    v_cvt_pk_bf16_f32 v6, v38, v39
    v_lshlrev_b32 v38, 16, v6
    v_and_b32 v39, s78, v6
    v_add_f32 v38, v38, v34
    v_add_f32 v39, v39, v35
    v_cvt_pk_bf16_f32 v41, v38, v39
    v_lshlrev_b32 v9, 3, v1
    v_add_u32 v9, 101376, v9
    ds_write_b64 v9, v[40:41]
    v_mov_b32 v4, 111620
    v_mov_b32 v5, 1
    s_waitcnt lgkmcnt(0)
    ds_write_b32 v4, v5
    v_and_b32 v15, 3, v13
    v_lshrrev_b32 v7, 3, v1
    v_and_b32 v8, 7, v1
    v_lshlrev_b32 v9, 15, v7
    v_lshl_add_u32 v9, v8, 4, v9
    s_lshl_b32 s10, s4, 7
    s_add_u32 s11, s10, 524288
    s_add_u32 s10, s10, 196608
    v_lshlrev_b32 v10, 4, v1
    v_mov_b32 v4, 111624
    s_mov_b32 s81, 4000000
Lw_25:
    ds_read_b32 v5, v4
    s_waitcnt lgkmcnt(0)
    v_cmp_ne_u32 vcc, 0, v5
    s_cbranch_vccnz Lwd_26
    s_sleep 1
    s_sub_u32 s81, s81, 1
    s_cbranch_scc0 Lw_25
Lwd_26:
    v_readfirstlane_b32 s101, v5
    v_mov_b32 v4, 111620
    s_mov_b32 s81, 4000000
Lw_27:
    ds_read_b32 v5, v4
    s_waitcnt lgkmcnt(0)
    v_cmp_eq_u32 vcc, 2, v5
    s_cbranch_vccnz Lwd_28
    s_sleep 1
    s_sub_u32 s81, s81, 1
    s_cbranch_scc0 Lw_27
Lwd_28:
    s_mov_b32 s81, 200007
Lpoll_29:
    buffer_load_dwordx4 v[32:35], v9, s[52:55], s10 offen sc1
Lchk_31:
    s_waitcnt vmcnt(0)
    v_xor_b32 v32, v15, v32
    v_xor_b32 v33, v15, v33
    v_xor_b32 v34, v15, v34
    v_xor_b32 v35, v15, v35
    v_or_b32 v12, v32, v33
    v_or3_b32 v12, v12, v34, v35
    v_and_b32 v12, 3, v12
    s_nop 1
    v_or_b32_dpp v12, v12, v12 quad_perm:[1,0,3,2] row_mask:0xf bank_mask:0xf
    s_nop 1
    v_or_b32_dpp v12, v12, v12 quad_perm:[2,3,0,1] row_mask:0xf bank_mask:0xf
    s_nop 1
    v_or_b32_dpp v12, v12, v12 row_half_mirror row_mask:0xf bank_mask:0xf
    v_cmp_ne_u32 vcc, 0, v12
    s_cbranch_vccz Ldone_30
    s_mov_b64 exec, vcc
    s_sub_u32 s81, s81, 1
    s_cbranch_scc0 Lpoll_29
Ldone_30:
    s_mov_b64 exec, -1
    v_permlane32_swap_b32 v32, v33
    v_permlane32_swap_b32 v34, v35
    v_add_f32 v32, v32, v33
    v_add_f32 v34, v34, v35
    s_nop 1
    v_permlane16_swap_b32 v32, v34
    v_add_f32 v32, v32, v34
    s_nop 1
    v_add_f32_dpp v32, v32, v32 row_ror:8 row_mask:0xf bank_mask:0xf
    v_cvt_pk_bf16_f32 v32, v32, v32
    v_bfi_b32 v32, s78, v32, v13
    v_mov_b32 v33, v32
    s_nop 1
    v_permlane32_swap_b32 v32, v33
    v_mov_b32 v34, v32
    v_mov_b32 v35, v33
    s_nop 0
    v_permlane16_swap_b32 v32, v34
    v_permlane16_swap_b32 v33, v35
    s_mov_b64 exec, 0xff
    s_cmp_eq_u32 s101, 1
    s_cbranch_scc1 Lsg_32
    buffer_store_dwordx4 v[32:35], v10, s[52:55], s11 offen sc1
    s_branch Lsgd_33
Lsg_32:
    buffer_store_dwordx4 v[32:35], v10, s[52:55], s11 offen
Lsgd_33:
    s_mov_b64 exec, -1
    v_mov_b32 v4, 111620
    v_mov_b32 v5, 3
    ds_write_b32 v4, v5
    s_waitcnt lgkmcnt(0)
    s_branch L_fin
L_chain:
    s_setprio 3
    v_lshrrev_b32 v11, 4, v1
    v_lshlrev_b32 v8, 13, v11
    v_and_b32 v15, 15, v1
    v_lshl_add_u32 v8, v15, 4, v8
    v_lshlrev_b32 v6, 5, v11
    v_xor_b32 v8, v8, v6
    v_xor_b32 v9, 0x80, v8
    s_lshl_b32 s10, s5, 20
    s_lshl_b32 s11, s6, 8
    s_add_u32 s10, s10, s11
    s_mov_b32 m0, 0
    s_waitcnt lgkmcnt(0)
    s_mov_b32 s56, s22
    s_mov_b32 s57, s23
    s_mov_b32 s58, 8388608
    s_mov_b32 s59, 0x20000
    s_mov_b32 s52, s42
    s_mov_b32 s53, s43
    s_mov_b32 s54, 268435456
    s_mov_b32 s55, 0x20000
    s_load_dword s82, s[42:43], 0
    s_barrier
L_wql:
    buffer_load_dwordx4 v8, s[56:59], s10 offen nt lds
    s_add_u32 m0, m0, 1024
    s_add_u32 s10, s10, 32768
    buffer_load_dwordx4 v8, s[56:59], s10 offen nt lds
    s_add_u32 m0, m0, 1024
    s_add_u32 s10, s10, 32768
    buffer_load_dwordx4 v9, s[56:59], s10 offen nt lds
    s_add_u32 m0, m0, 1024
    s_add_u32 s10, s10, 32768
    buffer_load_dwordx4 v9, s[56:59], s10 offen nt lds
    s_add_u32 m0, m0, 1024
    s_add_u32 s10, s10, 32768
    s_cmp_lt_u32 m0, 32768
    s_cbranch_scc1 L_wql
    s_waitcnt lgkmcnt(0)
    s_add_u32 s82, s82, 1
    s_and_b32 s8, s82, 1023
    v_mov_b32 v13, s8
    v_and_b32 v6, 1, v1
    v_lshlrev_b32 v8, 8, v6
    v_lshl_add_u32 v8, v11, 4, v8
    v_add_u32 v8, 101376, v8
    v_bfe_u32 v7, v1, 2, 2
    v_lshl_add_u32 v7, v11, 3, v7
    v_lshlrev_b32 v7, 8, v7
    v_and_b32 v10, 3, v1
    v_lshl_add_u32 v7, v10, 3, v7
    v_bfe_u32 v10, v1, 2, 3
    v_lshlrev_b32 v10, 5, v10
    v_xor_b32 v7, v7, v10
    v_lshrrev_b32 v9, 1, v15
    v_lshl_add_u32 v9, v11, 3, v9
    v_lshlrev_b32 v9, 4, v9
    v_lshl_add_u32 v9, v6, 14, v9
    s_lshl_b32 s10, s5, 15
    s_lshl_b32 s11, s6, 9
    s_add_u32 s10, s10, s11
    s_add_u32 s10, s10, 196608
    s_waitcnt vmcnt(0)
    v_xor_b32 v10, 0, v7
    ds_read_b64_tr_b16 v[40:41], v10 offset:0
    ds_read_b64_tr_b16 v[42:43], v10 offset:1024
    ds_read_b64_tr_b16 v[44:45], v10 offset:8192
    ds_read_b64_tr_b16 v[46:47], v10 offset:9216
    ds_read_b64_tr_b16 v[48:49], v10 offset:16384
    ds_read_b64_tr_b16 v[50:51], v10 offset:17408
    ds_read_b64_tr_b16 v[52:53], v10 offset:24576
    ds_read_b64_tr_b16 v[54:55], v10 offset:25600
    v_xor_b32 v10, 32, v7
    ds_read_b64_tr_b16 v[56:57], v10 offset:0
    ds_read_b64_tr_b16 v[58:59], v10 offset:1024
    ds_read_b64_tr_b16 v[60:61], v10 offset:8192
    ds_read_b64_tr_b16 v[62:63], v10 offset:9216
    ds_read_b64_tr_b16 v[64:65], v10 offset:16384
    ds_read_b64_tr_b16 v[66:67], v10 offset:17408
    ds_read_b64_tr_b16 v[68:69], v10 offset:24576
    ds_read_b64_tr_b16 v[70:71], v10 offset:25600
    v_xor_b32 v10, 64, v7
    ds_read_b64_tr_b16 v[72:73], v10 offset:0
    ds_read_b64_tr_b16 v[74:75], v10 offset:1024
    ds_read_b64_tr_b16 v[76:77], v10 offset:8192
    ds_read_b64_tr_b16 v[78:79], v10 offset:9216
    ds_read_b64_tr_b16 v[80:81], v10 offset:16384
    ds_read_b64_tr_b16 v[82:83], v10 offset:17408
    ds_read_b64_tr_b16 v[84:85], v10 offset:24576
    ds_read_b64_tr_b16 v[86:87], v10 offset:25600
    v_xor_b32 v10, 96, v7
    ds_read_b64_tr_b16 v[88:89], v10 offset:0
    ds_read_b64_tr_b16 v[90:91], v10 offset:1024
    ds_read_b64_tr_b16 v[92:93], v10 offset:8192
    ds_read_b64_tr_b16 v[94:95], v10 offset:9216
    ds_read_b64_tr_b16 v[96:97], v10 offset:16384
    ds_read_b64_tr_b16 v[98:99], v10 offset:17408
    ds_read_b64_tr_b16 v[100:101], v10 offset:24576
    ds_read_b64_tr_b16 v[102:103], v10 offset:25600
    v_xor_b32 v10, 128, v7
    ds_read_b64_tr_b16 v[104:105], v10 offset:0
    ds_read_b64_tr_b16 v[106:107], v10 offset:1024
    ds_read_b64_tr_b16 v[108:109], v10 offset:8192
    ds_read_b64_tr_b16 v[110:111], v10 offset:9216
    ds_read_b64_tr_b16 v[112:113], v10 offset:16384
    ds_read_b64_tr_b16 v[114:115], v10 offset:17408
    ds_read_b64_tr_b16 v[116:117], v10 offset:24576
    ds_read_b64_tr_b16 v[118:119], v10 offset:25600
    v_xor_b32 v10, 160, v7
    ds_read_b64_tr_b16 v[120:121], v10 offset:0
    ds_read_b64_tr_b16 v[122:123], v10 offset:1024
    ds_read_b64_tr_b16 v[124:125], v10 offset:8192
    ds_read_b64_tr_b16 v[126:127], v10 offset:9216
    ds_read_b64_tr_b16 v[128:129], v10 offset:16384
    ds_read_b64_tr_b16 v[130:131], v10 offset:17408
    ds_read_b64_tr_b16 v[132:133], v10 offset:24576
    ds_read_b64_tr_b16 v[134:135], v10 offset:25600
    v_xor_b32 v10, 192, v7
    ds_read_b64_tr_b16 v[136:137], v10 offset:0
    ds_read_b64_tr_b16 v[138:139], v10 offset:1024
    ds_read_b64_tr_b16 v[140:141], v10 offset:8192
    ds_read_b64_tr_b16 v[142:143], v10 offset:9216
    ds_read_b64_tr_b16 v[144:145], v10 offset:16384
    ds_read_b64_tr_b16 v[146:147], v10 offset:17408
    ds_read_b64_tr_b16 v[148:149], v10 offset:24576
    ds_read_b64_tr_b16 v[150:151], v10 offset:25600
    v_xor_b32 v10, 224, v7
    ds_read_b64_tr_b16 v[152:153], v10 offset:0
    ds_read_b64_tr_b16 v[154:155], v10 offset:1024
    ds_read_b64_tr_b16 v[156:157], v10 offset:8192
    ds_read_b64_tr_b16 v[158:159], v10 offset:9216
    ds_read_b64_tr_b16 v[160:161], v10 offset:16384
    ds_read_b64_tr_b16 v[162:163], v10 offset:17408
    ds_read_b64_tr_b16 v[164:165], v10 offset:24576
    ds_read_b64_tr_b16 v[166:167], v10 offset:25600
    v_mov_b32 v4, 111620
    s_mov_b32 s81, 4000000
Lw_34:
    ds_read_b32 v5, v4
    s_waitcnt lgkmcnt(0)
    v_cmp_eq_u32 vcc, 1, v5
    s_cbranch_vccnz Lwd_35
    s_sleep 1
    s_sub_u32 s81, s81, 1
    s_cbranch_scc0 Lw_34
Lwd_35:
    ds_read_b128 v[16:19], v8 offset:0
    ds_read_b128 v[20:23], v8 offset:64
    ds_read_b128 v[24:27], v8 offset:128
    ds_read_b128 v[28:31], v8 offset:192
    s_waitcnt lgkmcnt(0)
    v_mfma_f32_16x16x32_bf16 v[32:35], v[40:43], v[16:19], 0
    v_mfma_f32_16x16x32_bf16 v[32:35], v[44:47], v[20:23], v[32:35]
    v_mfma_f32_16x16x32_bf16 v[32:35], v[48:51], v[24:27], v[32:35]
    v_mfma_f32_16x16x32_bf16 v[32:35], v[52:55], v[28:31], v[32:35]
    v_mfma_f32_16x16x32_bf16 v[36:39], v[56:59], v[16:19], 0
    v_mfma_f32_16x16x32_bf16 v[36:39], v[60:63], v[20:23], v[36:39]
    v_mfma_f32_16x16x32_bf16 v[36:39], v[64:67], v[24:27], v[36:39]
    v_mfma_f32_16x16x32_bf16 v[36:39], v[68:71], v[28:31], v[36:39]
    s_mov_b32 exec_lo, 0x30003
    s_mov_b32 exec_hi, 0x30003
    s_nop 1
    v_mov_b32 v2, v32
    v_mov_b32 v3, v33
    v_mov_b32 v4, v34
    v_mov_b32 v5, v35
    s_mov_b64 exec, -1
    v_mfma_f32_16x16x32_bf16 v[32:35], v[72:75], v[16:19], 0
    v_mfma_f32_16x16x32_bf16 v[32:35], v[76:79], v[20:23], v[32:35]
    v_mfma_f32_16x16x32_bf16 v[32:35], v[80:83], v[24:27], v[32:35]
    v_mfma_f32_16x16x32_bf16 v[32:35], v[84:87], v[28:31], v[32:35]
    s_mov_b32 exec_lo, 0xc000c
    s_mov_b32 exec_hi, 0xc000c
    v_mov_b32 v2, v36
    v_mov_b32 v3, v37
    v_mov_b32 v4, v38
    v_mov_b32 v5, v39
    s_mov_b64 exec, -1
    v_mfma_f32_16x16x32_bf16 v[36:39], v[88:91], v[16:19], 0
    v_mfma_f32_16x16x32_bf16 v[36:39], v[92:95], v[20:23], v[36:39]
    v_mfma_f32_16x16x32_bf16 v[36:39], v[96:99], v[24:27], v[36:39]
    v_mfma_f32_16x16x32_bf16 v[36:39], v[100:103], v[28:31], v[36:39]
    s_mov_b32 exec_lo, 0x300030
    s_mov_b32 exec_hi, 0x300030
    v_mov_b32 v2, v32
    v_mov_b32 v3, v33
    v_mov_b32 v4, v34
    v_mov_b32 v5, v35
    s_mov_b64 exec, -1
    v_mfma_f32_16x16x32_bf16 v[32:35], v[104:107], v[16:19], 0
    v_mfma_f32_16x16x32_bf16 v[32:35], v[108:111], v[20:23], v[32:35]
    v_mfma_f32_16x16x32_bf16 v[32:35], v[112:115], v[24:27], v[32:35]
    v_mfma_f32_16x16x32_bf16 v[32:35], v[116:119], v[28:31], v[32:35]
    s_mov_b32 exec_lo, 0xc000c0
    s_mov_b32 exec_hi, 0xc000c0
    v_mov_b32 v2, v36
    v_mov_b32 v3, v37
    v_mov_b32 v4, v38
    v_mov_b32 v5, v39
    s_mov_b64 exec, -1
    v_mfma_f32_16x16x32_bf16 v[36:39], v[120:123], v[16:19], 0
    v_mfma_f32_16x16x32_bf16 v[36:39], v[124:127], v[20:23], v[36:39]
    v_mfma_f32_16x16x32_bf16 v[36:39], v[128:131], v[24:27], v[36:39]
    v_mfma_f32_16x16x32_bf16 v[36:39], v[132:135], v[28:31], v[36:39]
    s_mov_b32 exec_lo, 0x3000300
    s_mov_b32 exec_hi, 0x3000300
    v_mov_b32 v2, v32
    v_mov_b32 v3, v33
    v_mov_b32 v4, v34
    v_mov_b32 v5, v35
    s_mov_b64 exec, -1
    v_mfma_f32_16x16x32_bf16 v[32:35], v[136:139], v[16:19], 0
    v_mfma_f32_16x16x32_bf16 v[32:35], v[140:143], v[20:23], v[32:35]
    v_mfma_f32_16x16x32_bf16 v[32:35], v[144:147], v[24:27], v[32:35]
    v_mfma_f32_16x16x32_bf16 v[32:35], v[148:151], v[28:31], v[32:35]
    s_mov_b32 exec_lo, 0xc000c00
    s_mov_b32 exec_hi, 0xc000c00
    v_mov_b32 v2, v36
    v_mov_b32 v3, v37
    v_mov_b32 v4, v38
    v_mov_b32 v5, v39
    s_mov_b64 exec, -1
    v_mfma_f32_16x16x32_bf16 v[36:39], v[152:155], v[16:19], 0
    v_mfma_f32_16x16x32_bf16 v[36:39], v[156:159], v[20:23], v[36:39]
    v_mfma_f32_16x16x32_bf16 v[36:39], v[160:163], v[24:27], v[36:39]
    v_mfma_f32_16x16x32_bf16 v[36:39], v[164:167], v[28:31], v[36:39]
    s_mov_b32 exec_lo, 0x30003000
    s_mov_b32 exec_hi, 0x30003000
    v_mov_b32 v2, v32
    v_mov_b32 v3, v33
    v_mov_b32 v4, v34
    v_mov_b32 v5, v35
    s_mov_b64 exec, -1
    s_mov_b32 exec_lo, 0xc000c000
    s_mov_b32 exec_hi, 0xc000c000
    v_mov_b32 v2, v36
    v_mov_b32 v3, v37
    v_mov_b32 v4, v38
    v_mov_b32 v5, v39
    s_mov_b64 exec, -1
    v_add_u32 v2, 2, v2
    v_bfi_b32 v2, 3, v13, v2
    v_add_u32 v3, 2, v3
    v_bfi_b32 v3, 3, v13, v3
    v_add_u32 v4, 2, v4
    v_bfi_b32 v4, 3, v13, v4
    v_add_u32 v5, 2, v5
    v_bfi_b32 v5, 3, v13, v5
    buffer_store_dwordx4 v[2:5], v9, s[52:55], s10 offen sc1
    v_mov_b32 v8, 111620
    v_mov_b32 v7, 2
    ds_write_b32 v8, v7
    s_waitcnt lgkmcnt(0)
    s_branch L_fin
L_att:
    s_lshl_b32 s87, s4, 18
    s_lshl_b32 s9, s3, 12
    s_add_u32 s87, s87, s9
    s_and_b32 s9, s6, 7
    s_mul_i32 s9, s9, 32768
    s_add_u32 s87, s87, s9
    v_lshlrev_b32 v3, 4, v1
    v_and_b32 v6, 3, v1
    v_lshlrev_b32 v6, 10, v6
    v_bfe_u32 v5, v1, 2, 1
    v_lshl_add_u32 v6, v5, 8, v6
    v_lshl_add_u32 v2, v7, 4, v6
    v_mov_b32 v4, 111616
    s_mov_b64 vcc, 0
    s_waitcnt lgkmcnt(0)
    s_mov_b32 s44, s18
    s_mov_b32 s45, s19
    s_mov_b32 s46, 67108864
    s_mov_b32 s47, 0x20000
    s_mov_b32 s48, s20
    s_mov_b32 s49, s21
    s_mov_b32 s50, 67108864
    s_mov_b32 s51, 0x20000
    s_mov_b32 s52, s42
    s_mov_b32 s53, s43
    s_mov_b32 s54, 268435456
    s_mov_b32 s55, 0x20000
    s_barrier
    s_load_dword s82, s[42:43], 0
    s_xor_b32 s9, s87, 0
    s_waitcnt vmcnt(3)
    buffer_load_dwordx4 v[72:75], v2, s[44:47], s9 offen offset:0 nt
    s_waitcnt vmcnt(3)
    buffer_load_dwordx4 v[76:79], v2, s[44:47], s9 offen offset:128 nt
    s_waitcnt vmcnt(3)
    buffer_load_dwordx4 v[80:83], v2, s[44:47], s9 offen offset:512 nt
    s_waitcnt vmcnt(3)
    buffer_load_dwordx4 v[84:87], v2, s[44:47], s9 offen offset:640 nt
    s_xor_b32 s9, s87, 32768
    s_waitcnt vmcnt(3)
    buffer_load_dwordx4 v[88:91], v2, s[44:47], s9 offen offset:0 nt
    s_waitcnt vmcnt(3)
    buffer_load_dwordx4 v[92:95], v2, s[44:47], s9 offen offset:128 nt
    s_waitcnt vmcnt(3)
    buffer_load_dwordx4 v[96:99], v2, s[44:47], s9 offen offset:512 nt
    s_waitcnt vmcnt(3)
    buffer_load_dwordx4 v[100:103], v2, s[44:47], s9 offen offset:640 nt
    s_xor_b32 s9, s87, 65536
    s_waitcnt vmcnt(3)
    buffer_load_dwordx4 v[40:43], v2, s[44:47], s9 offen offset:0 nt
    s_waitcnt vmcnt(3)
    buffer_load_dwordx4 v[44:47], v2, s[44:47], s9 offen offset:128 nt
    s_waitcnt vmcnt(3)
    buffer_load_dwordx4 v[48:51], v2, s[44:47], s9 offen offset:512 nt
    s_waitcnt vmcnt(3)
    buffer_load_dwordx4 v[52:55], v2, s[44:47], s9 offen offset:640 nt
    s_xor_b32 s9, s87, 98304
    s_waitcnt vmcnt(3)
    buffer_load_dwordx4 v[56:59], v2, s[44:47], s9 offen offset:0 nt
    s_waitcnt vmcnt(3)
    buffer_load_dwordx4 v[60:63], v2, s[44:47], s9 offen offset:128 nt
    s_waitcnt vmcnt(3)
    buffer_load_dwordx4 v[64:67], v2, s[44:47], s9 offen offset:512 nt
    s_waitcnt vmcnt(3)
    buffer_load_dwordx4 v[68:71], v2, s[44:47], s9 offen offset:640 nt
    s_xor_b32 s9, s87, 131072
    s_waitcnt vmcnt(3)
    buffer_load_dwordx4 v[104:107], v2, s[44:47], s9 offen offset:0 nt
    s_waitcnt vmcnt(3)
    buffer_load_dwordx4 v[108:111], v2, s[44:47], s9 offen offset:128 nt
    s_waitcnt vmcnt(3)
    buffer_load_dwordx4 v[112:115], v2, s[44:47], s9 offen offset:512 nt
    s_waitcnt vmcnt(3)
    buffer_load_dwordx4 v[116:119], v2, s[44:47], s9 offen offset:640 nt
    s_xor_b32 s9, s87, 163840
    s_waitcnt vmcnt(3)
    buffer_load_dwordx4 v[120:123], v2, s[44:47], s9 offen offset:0 nt
    s_waitcnt vmcnt(3)
    buffer_load_dwordx4 v[124:127], v2, s[44:47], s9 offen offset:128 nt
    s_waitcnt vmcnt(3)
    buffer_load_dwordx4 v[128:131], v2, s[44:47], s9 offen offset:512 nt
    s_waitcnt vmcnt(3)
    buffer_load_dwordx4 v[132:135], v2, s[44:47], s9 offen offset:640 nt
    s_xor_b32 s9, s87, 196608
    s_waitcnt vmcnt(3)
    buffer_load_dwordx4 v[136:139], v2, s[44:47], s9 offen offset:0 nt
    s_waitcnt vmcnt(3)
    buffer_load_dwordx4 v[140:143], v2, s[44:47], s9 offen offset:128 nt
    s_waitcnt vmcnt(3)
    buffer_load_dwordx4 v[144:147], v2, s[44:47], s9 offen offset:512 nt
    s_waitcnt vmcnt(3)
    buffer_load_dwordx4 v[148:151], v2, s[44:47], s9 offen offset:640 nt
    s_xor_b32 s9, s87, 229376
    s_waitcnt vmcnt(3)
    buffer_load_dwordx4 v[152:155], v2, s[44:47], s9 offen offset:0 nt
    s_waitcnt vmcnt(3)
    buffer_load_dwordx4 v[156:159], v2, s[44:47], s9 offen offset:128 nt
    s_waitcnt vmcnt(3)
    buffer_load_dwordx4 v[160:163], v2, s[44:47], s9 offen offset:512 nt
    s_waitcnt vmcnt(3)
    buffer_load_dwordx4 v[164:167], v2, s[44:47], s9 offen offset:640 nt
    s_waitcnt lgkmcnt(0)
    s_add_u32 s82, s82, 1
    s_and_b32 s8, s82, 1023
    v_mov_b32 v13, s8
    v_lshrrev_b32 v2, 4, v1
    v_and_b32 v5, 15, v1
    s_bitcmp1_b32 s6, 0
    s_cbranch_scc1 Lts_36
    s_mov_b32 s64, s24
    s_mov_b32 s65, s25
    s_mov_b32 s66, 8388608
    s_mov_b32 s67, 0x20000
    s_mov_b32 s20, 64
    s_mov_b32 s16, 3
    s_mov_b32 s17, 4
    s_lshl_b32 s18, s7, 19
    s_lshl_b32 s9, s5, 8
    s_add_u32 s18, s18, s9
    s_mov_b32 s19, 2048
    s_branch Lts_37
Lts_36:
    s_cmp_ge_u32 s86, 112
    s_cselect_b32 s20, 0, 64
    s_mov_b32 s16, 0
    s_mov_b32 s17, 1
    v_lshlrev_b32 v4, 1, v2
    v_xor_b32 v5, v5, v4
    s_mov_b32 s64, s28
    s_mov_b32 s65, s29
    s_mov_b32 s66, 7340032
    s_mov_b32 s67, 0x20000
    s_and_b32 s18, s86, 3
    s_mul_i32 s18, s18, 1835008
    s_lshr_b32 s9, s86, 2
    s_lshl_b32 s9, s9, 8
    s_add_u32 s18, s18, s9
    s_mov_b32 s19, 7168
Lts_37:
    v_mul_lo_u32 v2, v2, s19
    v_lshl_add_u32 v2, v5, 4, v2
    s_lshl_b32 s19, s19, 2
    v_mov_b32 v4, 111616
    s_mov_b32 s81, 4000000
Lw_38:
    ds_read_b32 v5, v4
    s_waitcnt lgkmcnt(0)
    v_cmp_eq_u32 vcc, 2, v5
    s_cbranch_vccnz Lwd_39
    s_sleep 1
    s_sub_u32 s81, s81, 1
    s_cbranch_scc0 Lw_38
Lwd_39:
L_filld:
    v_and_b32 v8, 7, v1
    v_lshlrev_b32 v9, 8, v8
    v_lshl_add_u32 v9, v7, 4, v9
    v_add_u32 v9, 99328, v9
    ds_read_b128 v[16:19], v9
    ds_read_b128 v[20:23], v9 offset:128
    s_waitcnt lgkmcnt(0)
    s_waitcnt vmcnt(28)
    v_mfma_f32_16x16x32_bf16 v[32:35], v[72:75], v[16:19], 0
    v_mfma_f32_16x16x32_bf16 v[24:27], v[80:83], v[16:19], 0
    v_mfma_f32_16x16x32_bf16 v[32:35], v[76:79], v[20:23], v[32:35]
    v_mfma_f32_16x16x32_bf16 v[24:27], v[84:87], v[20:23], v[24:27]
    s_waitcnt vmcnt(24)
    v_mfma_f32_16x16x32_bf16 v[36:39], v[88:91], v[16:19], 0
    v_mfma_f32_16x16x32_bf16 v[28:31], v[96:99], v[16:19], 0
    v_mfma_f32_16x16x32_bf16 v[36:39], v[92:95], v[20:23], v[36:39]
    v_mfma_f32_16x16x32_bf16 v[28:31], v[100:103], v[20:23], v[28:31]
    s_xor_b32 s72, s87, 0
    s_waitcnt vmcnt(5)
    buffer_load_dwordx4 v[72:75], v3, s[48:51], s72 offen offset:0 nt
    v_permlane32_swap_b32 v32, v24
    v_permlane32_swap_b32 v33, v25
    v_permlane32_swap_b32 v34, v26
    v_permlane32_swap_b32 v35, v27
    v_add_f32_dpp v32, v24, v32 row_ror:8 row_mask:0xf bank_mask:0xf
    v_add_f32_dpp v33, v25, v33 row_ror:8 row_mask:0xf bank_mask:0xf
    v_add_f32_dpp v34, v26, v34 row_ror:8 row_mask:0xf bank_mask:0xf
    v_add_f32_dpp v35, v27, v35 row_ror:8 row_mask:0xf bank_mask:0xf
    v_cvt_pk_bf16_f32 v4, v32, v33
    v_lshlrev_b32 v32, 16, v4
    v_and_b32 v33, s78, v4
    v_mul_f32 v32, s80, v32
    v_mul_f32 v33, s80, v33
    v_cvt_pk_bf16_f32 v4, v32, v33
    v_lshlrev_b32 v32, 16, v4
    v_and_b32 v33, s78, v4
    v_cvt_pk_bf16_f32 v4, v34, v35
    v_lshlrev_b32 v34, 16, v4
    v_and_b32 v35, s78, v4
    v_mul_f32 v34, s80, v34
    v_mul_f32 v35, s80, v35
    v_cvt_pk_bf16_f32 v4, v34, v35
    v_lshlrev_b32 v34, 16, v4
    v_and_b32 v35, s78, v4
    v_max3_f32 v5, v32, v33, v34
    v_max_f32 v5, v5, v35
    s_waitcnt vmcnt(5)
    buffer_load_dwordx4 v[76:79], v3, s[48:51], s72 offen offset:1024 nt
    v_permlane32_swap_b32 v36, v28
    v_permlane32_swap_b32 v37, v29
    v_permlane32_swap_b32 v38, v30
    v_permlane32_swap_b32 v39, v31
    v_add_f32_dpp v36, v28, v36 row_ror:8 row_mask:0xf bank_mask:0xf
    v_add_f32_dpp v37, v29, v37 row_ror:8 row_mask:0xf bank_mask:0xf
    v_add_f32_dpp v38, v30, v38 row_ror:8 row_mask:0xf bank_mask:0xf
    v_add_f32_dpp v39, v31, v39 row_ror:8 row_mask:0xf bank_mask:0xf
    v_cvt_pk_bf16_f32 v4, v36, v37
    v_lshlrev_b32 v36, 16, v4
    v_and_b32 v37, s78, v4
    v_mul_f32 v36, s80, v36
    v_mul_f32 v37, s80, v37
    v_cvt_pk_bf16_f32 v4, v36, v37
    v_lshlrev_b32 v36, 16, v4
    v_and_b32 v37, s78, v4
    v_cvt_pk_bf16_f32 v4, v38, v39
    v_lshlrev_b32 v38, 16, v4
    v_and_b32 v39, s78, v4
    v_mul_f32 v38, s80, v38
    v_mul_f32 v39, s80, v39
    v_cvt_pk_bf16_f32 v4, v38, v39
    v_lshlrev_b32 v38, 16, v4
    v_and_b32 v39, s78, v4
    v_max3_f32 v5, v5, v36, v37
    v_max3_f32 v5, v5, v38, v39
    s_waitcnt vmcnt(5)
    buffer_load_dwordx4 v[80:83], v3, s[48:51], s72 offen offset:2048 nt
    s_waitcnt vmcnt(23)
    v_mfma_f32_16x16x32_bf16 v[24:27], v[40:43], v[16:19], 0
    v_mfma_f32_16x16x32_bf16 v[28:31], v[48:51], v[16:19], 0
    v_mfma_f32_16x16x32_bf16 v[24:27], v[44:47], v[20:23], v[24:27]
    v_mfma_f32_16x16x32_bf16 v[28:31], v[52:55], v[20:23], v[28:31]
    s_nop 7
    v_permlane32_swap_b32 v24, v28
    v_permlane32_swap_b32 v25, v29
    v_permlane32_swap_b32 v26, v30
    v_permlane32_swap_b32 v27, v31
    v_add_f32_dpp v40, v28, v24 row_ror:8 row_mask:0xf bank_mask:0xf
    v_add_f32_dpp v41, v29, v25 row_ror:8 row_mask:0xf bank_mask:0xf
    v_add_f32_dpp v42, v30, v26 row_ror:8 row_mask:0xf bank_mask:0xf
    v_add_f32_dpp v43, v31, v27 row_ror:8 row_mask:0xf bank_mask:0xf
    v_cvt_pk_bf16_f32 v4, v40, v41
    v_lshlrev_b32 v40, 16, v4
    v_and_b32 v41, s78, v4
    v_mul_f32 v40, s80, v40
    v_mul_f32 v41, s80, v41
    v_cvt_pk_bf16_f32 v4, v40, v41
    v_lshlrev_b32 v40, 16, v4
    v_and_b32 v41, s78, v4
    v_cvt_pk_bf16_f32 v4, v42, v43
    v_lshlrev_b32 v42, 16, v4
    v_and_b32 v43, s78, v4
    v_mul_f32 v42, s80, v42
    v_mul_f32 v43, s80, v43
    v_cvt_pk_bf16_f32 v4, v42, v43
    v_lshlrev_b32 v42, 16, v4
    v_and_b32 v43, s78, v4
    v_max3_f32 v5, v5, v40, v41
    v_max3_f32 v5, v5, v42, v43
    s_waitcnt vmcnt(5)
    buffer_load_dwordx4 v[84:87], v3, s[48:51], s72 offen offset:3072 nt
    s_waitcnt vmcnt(20)
    v_mfma_f32_16x16x32_bf16 v[24:27], v[56:59], v[16:19], 0
    v_mfma_f32_16x16x32_bf16 v[28:31], v[64:67], v[16:19], 0
    v_mfma_f32_16x16x32_bf16 v[24:27], v[60:63], v[20:23], v[24:27]
    v_mfma_f32_16x16x32_bf16 v[28:31], v[68:71], v[20:23], v[28:31]
    s_nop 7
    v_permlane32_swap_b32 v24, v28
    v_permlane32_swap_b32 v25, v29
    v_permlane32_swap_b32 v26, v30
    v_permlane32_swap_b32 v27, v31
    v_add_f32_dpp v44, v28, v24 row_ror:8 row_mask:0xf bank_mask:0xf
    v_add_f32_dpp v45, v29, v25 row_ror:8 row_mask:0xf bank_mask:0xf
    v_add_f32_dpp v46, v30, v26 row_ror:8 row_mask:0xf bank_mask:0xf
    v_add_f32_dpp v47, v31, v27 row_ror:8 row_mask:0xf bank_mask:0xf
    v_cvt_pk_bf16_f32 v4, v44, v45
    v_lshlrev_b32 v44, 16, v4
    v_and_b32 v45, s78, v4
    v_mul_f32 v44, s80, v44
    v_mul_f32 v45, s80, v45
    v_cvt_pk_bf16_f32 v4, v44, v45
    v_lshlrev_b32 v44, 16, v4
    v_and_b32 v45, s78, v4
    v_cvt_pk_bf16_f32 v4, v46, v47
    v_lshlrev_b32 v46, 16, v4
    v_and_b32 v47, s78, v4
    v_mul_f32 v46, s80, v46
    v_mul_f32 v47, s80, v47
    v_cvt_pk_bf16_f32 v4, v46, v47
    v_lshlrev_b32 v46, 16, v4
    v_and_b32 v47, s78, v4
    v_max3_f32 v5, v5, v44, v45
    v_max3_f32 v5, v5, v46, v47
    s_xor_b32 s72, s87, 32768
    s_waitcnt vmcnt(5)
    buffer_load_dwordx4 v[88:91], v3, s[48:51], s72 offen offset:0 nt
    s_waitcnt vmcnt(17)
    v_mfma_f32_16x16x32_bf16 v[24:27], v[104:107], v[16:19], 0
    v_mfma_f32_16x16x32_bf16 v[28:31], v[112:115], v[16:19], 0
    v_mfma_f32_16x16x32_bf16 v[24:27], v[108:111], v[20:23], v[24:27]
    v_mfma_f32_16x16x32_bf16 v[28:31], v[116:119], v[20:23], v[28:31]
    s_nop 7
    v_permlane32_swap_b32 v24, v28
    v_permlane32_swap_b32 v25, v29
    v_permlane32_swap_b32 v26, v30
    v_permlane32_swap_b32 v27, v31
    v_add_f32_dpp v48, v28, v24 row_ror:8 row_mask:0xf bank_mask:0xf
    v_add_f32_dpp v49, v29, v25 row_ror:8 row_mask:0xf bank_mask:0xf
    v_add_f32_dpp v50, v30, v26 row_ror:8 row_mask:0xf bank_mask:0xf
    v_add_f32_dpp v51, v31, v27 row_ror:8 row_mask:0xf bank_mask:0xf
    v_cvt_pk_bf16_f32 v4, v48, v49
    v_lshlrev_b32 v48, 16, v4
    v_and_b32 v49, s78, v4
    v_mul_f32 v48, s80, v48
    v_mul_f32 v49, s80, v49
    v_cvt_pk_bf16_f32 v4, v48, v49
    v_lshlrev_b32 v48, 16, v4
    v_and_b32 v49, s78, v4
    v_cvt_pk_bf16_f32 v4, v50, v51
    v_lshlrev_b32 v50, 16, v4
    v_and_b32 v51, s78, v4
    v_mul_f32 v50, s80, v50
    v_mul_f32 v51, s80, v51
    v_cvt_pk_bf16_f32 v4, v50, v51
    v_lshlrev_b32 v50, 16, v4
    v_and_b32 v51, s78, v4
    v_max3_f32 v5, v5, v48, v49
    v_max3_f32 v5, v5, v50, v51
    s_waitcnt vmcnt(5)
    buffer_load_dwordx4 v[92:95], v3, s[48:51], s72 offen offset:1024 nt
    s_waitcnt vmcnt(14)
    v_mfma_f32_16x16x32_bf16 v[24:27], v[120:123], v[16:19], 0
    v_mfma_f32_16x16x32_bf16 v[28:31], v[128:131], v[16:19], 0
    v_mfma_f32_16x16x32_bf16 v[24:27], v[124:127], v[20:23], v[24:27]
    v_mfma_f32_16x16x32_bf16 v[28:31], v[132:135], v[20:23], v[28:31]
    s_nop 7
    v_permlane32_swap_b32 v24, v28
    v_permlane32_swap_b32 v25, v29
    v_permlane32_swap_b32 v26, v30
    v_permlane32_swap_b32 v27, v31
    v_add_f32_dpp v52, v28, v24 row_ror:8 row_mask:0xf bank_mask:0xf
    v_add_f32_dpp v53, v29, v25 row_ror:8 row_mask:0xf bank_mask:0xf
    v_add_f32_dpp v54, v30, v26 row_ror:8 row_mask:0xf bank_mask:0xf
    v_add_f32_dpp v55, v31, v27 row_ror:8 row_mask:0xf bank_mask:0xf
    v_cvt_pk_bf16_f32 v4, v52, v53
    v_lshlrev_b32 v52, 16, v4
    v_and_b32 v53, s78, v4
    v_mul_f32 v52, s80, v52
    v_mul_f32 v53, s80, v53
    v_cvt_pk_bf16_f32 v4, v52, v53
    v_lshlrev_b32 v52, 16, v4
    v_and_b32 v53, s78, v4
    v_cvt_pk_bf16_f32 v4, v54, v55
    v_lshlrev_b32 v54, 16, v4
    v_and_b32 v55, s78, v4
    v_mul_f32 v54, s80, v54
    v_mul_f32 v55, s80, v55
    v_cvt_pk_bf16_f32 v4, v54, v55
    v_lshlrev_b32 v54, 16, v4
    v_and_b32 v55, s78, v4
    v_max3_f32 v5, v5, v52, v53
    v_max3_f32 v5, v5, v54, v55
    s_waitcnt vmcnt(5)
    buffer_load_dwordx4 v[96:99], v3, s[48:51], s72 offen offset:2048 nt
    s_waitcnt vmcnt(11)
    v_mfma_f32_16x16x32_bf16 v[24:27], v[136:139], v[16:19], 0
    v_mfma_f32_16x16x32_bf16 v[28:31], v[144:147], v[16:19], 0
    v_mfma_f32_16x16x32_bf16 v[24:27], v[140:143], v[20:23], v[24:27]
    v_mfma_f32_16x16x32_bf16 v[28:31], v[148:151], v[20:23], v[28:31]
    s_nop 7
    v_permlane32_swap_b32 v24, v28
    v_permlane32_swap_b32 v25, v29
    v_permlane32_swap_b32 v26, v30
    v_permlane32_swap_b32 v27, v31
    v_add_f32_dpp v56, v28, v24 row_ror:8 row_mask:0xf bank_mask:0xf
    v_add_f32_dpp v57, v29, v25 row_ror:8 row_mask:0xf bank_mask:0xf
    v_add_f32_dpp v58, v30, v26 row_ror:8 row_mask:0xf bank_mask:0xf
    v_add_f32_dpp v59, v31, v27 row_ror:8 row_mask:0xf bank_mask:0xf
    v_cvt_pk_bf16_f32 v4, v56, v57
    v_lshlrev_b32 v56, 16, v4
    v_and_b32 v57, s78, v4
    v_mul_f32 v56, s80, v56
    v_mul_f32 v57, s80, v57
    v_cvt_pk_bf16_f32 v4, v56, v57
    v_lshlrev_b32 v56, 16, v4
    v_and_b32 v57, s78, v4
    v_cvt_pk_bf16_f32 v4, v58, v59
    v_lshlrev_b32 v58, 16, v4
    v_and_b32 v59, s78, v4
    v_mul_f32 v58, s80, v58
    v_mul_f32 v59, s80, v59
    v_cvt_pk_bf16_f32 v4, v58, v59
    v_lshlrev_b32 v58, 16, v4
    v_and_b32 v59, s78, v4
    v_max3_f32 v5, v5, v56, v57
    v_max3_f32 v5, v5, v58, v59
    s_waitcnt vmcnt(5)
    buffer_load_dwordx4 v[100:103], v3, s[48:51], s72 offen offset:3072 nt
    s_waitcnt vmcnt(8)
    v_mfma_f32_16x16x32_bf16 v[24:27], v[152:155], v[16:19], 0
    v_mfma_f32_16x16x32_bf16 v[28:31], v[160:163], v[16:19], 0
    v_mfma_f32_16x16x32_bf16 v[24:27], v[156:159], v[20:23], v[24:27]
    v_mfma_f32_16x16x32_bf16 v[28:31], v[164:167], v[20:23], v[28:31]
    s_nop 7
    v_permlane32_swap_b32 v24, v28
    v_permlane32_swap_b32 v25, v29
    v_permlane32_swap_b32 v26, v30
    v_permlane32_swap_b32 v27, v31
    v_add_f32_dpp v60, v28, v24 row_ror:8 row_mask:0xf bank_mask:0xf
    v_add_f32_dpp v61, v29, v25 row_ror:8 row_mask:0xf bank_mask:0xf
    v_add_f32_dpp v62, v30, v26 row_ror:8 row_mask:0xf bank_mask:0xf
    v_add_f32_dpp v63, v31, v27 row_ror:8 row_mask:0xf bank_mask:0xf
    v_cvt_pk_bf16_f32 v4, v60, v61
    v_lshlrev_b32 v60, 16, v4
    v_and_b32 v61, s78, v4
    v_mul_f32 v60, s80, v60
    v_mul_f32 v61, s80, v61
    v_cvt_pk_bf16_f32 v4, v60, v61
    v_lshlrev_b32 v60, 16, v4
    v_and_b32 v61, s78, v4
    v_cvt_pk_bf16_f32 v4, v62, v63
    v_lshlrev_b32 v62, 16, v4
    v_and_b32 v63, s78, v4
    v_mul_f32 v62, s80, v62
    v_mul_f32 v63, s80, v63
    v_cvt_pk_bf16_f32 v4, v62, v63
    v_lshlrev_b32 v62, 16, v4
    v_and_b32 v63, s78, v4
    v_max3_f32 v5, v5, v60, v61
    v_max3_f32 v5, v5, v62, v63
    s_xor_b32 s72, s87, 65536
    s_waitcnt vmcnt(5)
    buffer_load_dwordx4 v[104:107], v3, s[48:51], s72 offen offset:0 nt
    v_mov_b32 v6, v5
    s_nop 1
    v_permlane32_swap_b32 v5, v6
    v_max_f32 v5, v5, v6
    v_mov_b32 v6, v5
    s_nop 1
    v_permlane16_swap_b32 v5, v6
    v_max_f32 v5, v5, v6
    v_lshlrev_b32 v9, 5, v8
    v_add_u32 v10, 102400, v9
    s_lshl_b32 s9, s3, 2
    v_add_u32 v11, s9, v10
    s_mov_b64 exec, 0xff
    ds_write_b32 v11, v5
    s_mov_b64 exec, -1
    s_waitcnt vmcnt(5)
    buffer_load_dwordx4 v[108:111], v3, s[48:51], s72 offen offset:1024 nt
    s_waitcnt lgkmcnt(0)
    s_barrier
    s_waitcnt vmcnt(5)
    buffer_load_dwordx4 v[112:115], v3, s[48:51], s72 offen offset:2048 nt
    v_mov_b32 v4, 111624
    ds_read_b128 v[16:19], v10
    ds_read_b128 v[20:23], v10 offset:16
    ds_read_b32 v4, v4
    s_waitcnt lgkmcnt(0)
    v_readfirstlane_b32 s101, v4
    v_max3_f32 v5, v16, v17, v18
    v_max3_f32 v5, v5, v19, v20
    v_max3_f32 v5, v5, v21, v22
    v_max_f32 v5, v5, v23
    v_mul_f32 v6, s79, v5
    v_mov_b32 v4, 0
    v_fma_f32 v32, v32, s79, -v6
    v_exp_f32 v32, v32
    v_fma_f32 v33, v33, s79, -v6
    v_exp_f32 v33, v33
    v_add_f32 v4, v4, v32
    v_fma_f32 v34, v34, s79, -v6
    v_exp_f32 v34, v34
    v_add_f32 v4, v4, v33
    v_fma_f32 v35, v35, s79, -v6
    v_exp_f32 v35, v35
    v_add_f32 v4, v4, v34
    v_fma_f32 v36, v36, s79, -v6
    v_exp_f32 v36, v36
    v_add_f32 v4, v4, v35
    v_fma_f32 v37, v37, s79, -v6
    v_exp_f32 v37, v37
    v_add_f32 v4, v4, v36
    v_fma_f32 v38, v38, s79, -v6
    v_exp_f32 v38, v38
    v_add_f32 v4, v4, v37
    v_fma_f32 v39, v39, s79, -v6
    v_exp_f32 v39, v39
    v_add_f32 v4, v4, v38
    s_waitcnt vmcnt(5)
    buffer_load_dwordx4 v[116:119], v3, s[48:51], s72 offen offset:3072 nt
    v_fma_f32 v40, v40, s79, -v6
    v_exp_f32 v40, v40
    v_add_f32 v4, v4, v39
    v_fma_f32 v41, v41, s79, -v6
    v_exp_f32 v41, v41
    v_add_f32 v4, v4, v40
    v_fma_f32 v42, v42, s79, -v6
    v_exp_f32 v42, v42
    v_add_f32 v4, v4, v41
    v_fma_f32 v43, v43, s79, -v6
    v_exp_f32 v43, v43
    v_add_f32 v4, v4, v42
    v_fma_f32 v44, v44, s79, -v6
    v_exp_f32 v44, v44
    v_add_f32 v4, v4, v43
    v_fma_f32 v45, v45, s79, -v6
    v_exp_f32 v45, v45
    v_add_f32 v4, v4, v44
    v_fma_f32 v46, v46, s79, -v6
    v_exp_f32 v46, v46
    v_add_f32 v4, v4, v45
    v_fma_f32 v47, v47, s79, -v6
    v_exp_f32 v47, v47
    v_add_f32 v4, v4, v46
    v_fma_f32 v48, v48, s79, -v6
    v_exp_f32 v48, v48
    v_add_f32 v4, v4, v47
    v_fma_f32 v49, v49, s79, -v6
    v_exp_f32 v49, v49
    v_add_f32 v4, v4, v48
    v_fma_f32 v50, v50, s79, -v6
    v_exp_f32 v50, v50
    v_add_f32 v4, v4, v49
    v_fma_f32 v51, v51, s79, -v6
    v_exp_f32 v51, v51
    v_add_f32 v4, v4, v50
    s_xor_b32 s72, s87, 98304
    s_waitcnt vmcnt(5)
    buffer_load_dwordx4 v[120:123], v3, s[48:51], s72 offen offset:0 nt
    v_fma_f32 v52, v52, s79, -v6
    v_exp_f32 v52, v52
    v_add_f32 v4, v4, v51
    v_fma_f32 v53, v53, s79, -v6
    v_exp_f32 v53, v53
    v_add_f32 v4, v4, v52
    v_fma_f32 v54, v54, s79, -v6
    v_exp_f32 v54, v54
    v_add_f32 v4, v4, v53
    v_fma_f32 v55, v55, s79, -v6
    v_exp_f32 v55, v55
    v_add_f32 v4, v4, v54
    v_fma_f32 v56, v56, s79, -v6
    v_exp_f32 v56, v56
    v_add_f32 v4, v4, v55
    v_fma_f32 v57, v57, s79, -v6
    v_exp_f32 v57, v57
    v_add_f32 v4, v4, v56
    v_fma_f32 v58, v58, s79, -v6
    v_exp_f32 v58, v58
    v_add_f32 v4, v4, v57
    v_fma_f32 v59, v59, s79, -v6
    v_exp_f32 v59, v59
    v_add_f32 v4, v4, v58
    v_fma_f32 v60, v60, s79, -v6
    v_exp_f32 v60, v60
    v_add_f32 v4, v4, v59
    v_fma_f32 v61, v61, s79, -v6
    v_exp_f32 v61, v61
    v_add_f32 v4, v4, v60
    v_fma_f32 v62, v62, s79, -v6
    v_exp_f32 v62, v62
    v_add_f32 v4, v4, v61
    v_fma_f32 v63, v63, s79, -v6
    v_exp_f32 v63, v63
    v_add_f32 v4, v4, v62
    v_add_f32 v4, v4, v63
    s_waitcnt vmcnt(5)
    buffer_load_dwordx4 v[124:127], v3, s[48:51], s72 offen offset:1024 nt
    v_cvt_pk_bf16_f32 v16, v32, v33
    v_cvt_pk_bf16_f32 v17, v34, v35
    v_cvt_pk_bf16_f32 v18, v36, v37
    v_cvt_pk_bf16_f32 v19, v38, v39
    v_cvt_pk_bf16_f32 v20, v40, v41
    v_cvt_pk_bf16_f32 v21, v42, v43
    v_cvt_pk_bf16_f32 v22, v44, v45
    v_cvt_pk_bf16_f32 v23, v46, v47
    v_cvt_pk_bf16_f32 v24, v48, v49
    v_cvt_pk_bf16_f32 v25, v50, v51
    v_cvt_pk_bf16_f32 v26, v52, v53
    v_cvt_pk_bf16_f32 v27, v54, v55
    v_cvt_pk_bf16_f32 v28, v56, v57
    v_cvt_pk_bf16_f32 v29, v58, v59
    v_cvt_pk_bf16_f32 v30, v60, v61
    v_cvt_pk_bf16_f32 v31, v62, v63
    s_mov_b32 exec_lo, 0xff00ff00
    s_mov_b32 exec_hi, 0xff00ff00
    v_mov_b32 v16, 0
    v_mov_b32 v17, 0
    v_mov_b32 v18, 0
    v_mov_b32 v19, 0
    v_mov_b32 v20, 0
    v_mov_b32 v21, 0
    v_mov_b32 v22, 0
    v_mov_b32 v23, 0
    v_mov_b32 v24, 0
    v_mov_b32 v25, 0
    v_mov_b32 v26, 0
    v_mov_b32 v27, 0
    v_mov_b32 v28, 0
    v_mov_b32 v29, 0
    v_mov_b32 v30, 0
    v_mov_b32 v31, 0
    s_mov_b64 exec, -1
    v_mov_b32_dpp v56, v16 row_ror:8 row_mask:0xf bank_mask:0xf
    v_mov_b32_dpp v57, v17 row_ror:8 row_mask:0xf bank_mask:0xf
    v_mov_b32_dpp v58, v18 row_ror:8 row_mask:0xf bank_mask:0xf
    v_mov_b32_dpp v59, v19 row_ror:8 row_mask:0xf bank_mask:0xf
    v_mov_b32_dpp v60, v20 row_ror:8 row_mask:0xf bank_mask:0xf
    v_mov_b32_dpp v61, v21 row_ror:8 row_mask:0xf bank_mask:0xf
    v_mov_b32_dpp v62, v22 row_ror:8 row_mask:0xf bank_mask:0xf
    v_mov_b32_dpp v63, v23 row_ror:8 row_mask:0xf bank_mask:0xf
    v_mov_b32_dpp v64, v24 row_ror:8 row_mask:0xf bank_mask:0xf
    v_mov_b32_dpp v65, v25 row_ror:8 row_mask:0xf bank_mask:0xf
    v_mov_b32_dpp v66, v26 row_ror:8 row_mask:0xf bank_mask:0xf
    v_mov_b32_dpp v67, v27 row_ror:8 row_mask:0xf bank_mask:0xf
    v_mov_b32_dpp v68, v28 row_ror:8 row_mask:0xf bank_mask:0xf
    v_mov_b32_dpp v69, v29 row_ror:8 row_mask:0xf bank_mask:0xf
    v_mov_b32_dpp v70, v30 row_ror:8 row_mask:0xf bank_mask:0xf
    v_mov_b32_dpp v71, v31 row_ror:8 row_mask:0xf bank_mask:0xf
    v_mov_b32 v6, v4
    s_nop 1
    v_permlane32_swap_b32 v4, v6
    v_add_f32 v4, v4, v6
    v_mov_b32 v6, v4
    s_nop 1
    v_permlane16_swap_b32 v4, v6
    v_add_f32 v4, v4, v6
    s_mov_b64 exec, 0xff
    ds_write_b32 v11, v4 offset:256
    s_mov_b64 exec, -1
    s_waitcnt vmcnt(5)
    buffer_load_dwordx4 v[128:131], v3, s[48:51], s72 offen offset:2048 nt
    s_waitcnt lgkmcnt(0)
    s_barrier
    s_waitcnt vmcnt(5)
    buffer_load_dwordx4 v[132:135], v3, s[48:51], s72 offen offset:3072 nt
    s_cmp_lg_u32 s3, 4
    s_cbranch_scc1 L_noml
    ds_read_b128 v[32:35], v10 offset:256
    ds_read_b128 v[36:39], v10 offset:272
    s_lshl_b32 s10, s4, 7
    s_add_u32 s10, s10, 4096
    v_lshlrev_b32 v9, 4, v8
    s_waitcnt lgkmcnt(0)
    v_add_f32 v32, v32, v33
    v_add_f32 v34, v34, v35
    v_add_f32 v36, v36, v37
    v_add_f32 v38, v38, v39
    v_add_f32 v32, v32, v34
    v_add_f32 v36, v36, v38
    v_add_f32 v33, v32, v36
    v_bfi_b32 v32, s83, v13, v5
    v_bfi_b32 v33, s83, v13, v33
    v_mov_b32 v34, v32
    v_mov_b32 v35, v33
    s_mov_b64 exec, 0xff
    s_cmp_eq_u32 s101, 1
    s_cbranch_scc1 Lsg_40
    buffer_store_dwordx4 v[32:35], v9, s[52:55], s10 offen sc1
    s_branch Lsgd_41
Lsg_40:
    buffer_store_dwordx4 v[32:35], v9, s[52:55], s10 offen
Lsgd_41:
    s_mov_b64 exec, -1
L_noml:
    v_mul_u32_u24 v9, 528, v8
    v_lshrrev_b32 v10, 4, v1
    v_lshl_add_u32 v9, v10, 4, v9
    v_bfe_u32 v10, v1, 3, 1
    v_lshl_add_u32 v9, v10, 8, v9
    s_mul_i32 s9, s3, 4224
    s_add_u32 s9, s9, 65536
    v_add_u32 v9, s9, v9
    v_lshrrev_b32 v10, 5, v1
    v_mul_u32_u24 v10, 16896, v10
    v_and_b32 v11, 31, v1
    v_lshlrev_b32 v11, 4, v11
    s_mul_i32 s9, s3, 528
    s_add_u32 s9, s9, 65536
    v_add3_u32 v10, v10, v11, s9
    s_lshl_b32 s10, s5, 3
    s_add_u32 s10, s10, s3
    s_lshl_b32 s10, s10, 5
    s_add_u32 s10, s10, s6
    s_lshl_b32 s11, s10, 9
    s_add_u32 s11, s11, 2097152
    s_mov_b32 s94, 0x00ff00ff
    s_mov_b32 s95, 0x00ff00ff
    s_waitcnt vmcnt(8)
    s_xor_b32 s72, s87, 131072
    s_waitcnt vmcnt(5)
    buffer_load_dwordx4 v[136:139], v3, s[48:51], s72 offen offset:0 nt
    v_perm_b32 v32, v76, v72, s76
    v_perm_b32 v33, v84, v80, s76
    v_perm_b32 v34, v92, v88, s76
    v_perm_b32 v35, v100, v96, s76
    s_nop 1
    v_mfma_f32_16x16x32_bf16 v[40:43], v[32:35], v[16:19], 0
    s_waitcnt vmcnt(5)
    buffer_load_dwordx4 v[140:143], v3, s[48:51], s72 offen offset:1024 nt
    v_perm_b32 v36, v76, v72, s77
    v_perm_b32 v37, v84, v80, s77
    v_perm_b32 v38, v92, v88, s77
    v_perm_b32 v39, v100, v96, s77
    s_nop 1
    v_mfma_f32_16x16x32_bf16 v[44:47], v[36:39], v[16:19], 0
    s_waitcnt vmcnt(5)
    buffer_load_dwordx4 v[144:147], v3, s[48:51], s72 offen offset:2048 nt
    v_perm_b32 v32, v77, v73, s76
    v_perm_b32 v33, v85, v81, s76
    v_perm_b32 v34, v93, v89, s76
    v_perm_b32 v35, v101, v97, s76
    s_nop 1
    v_mfma_f32_16x16x32_bf16 v[48:51], v[32:35], v[16:19], 0
    s_waitcnt vmcnt(5)
    buffer_load_dwordx4 v[148:151], v3, s[48:51], s72 offen offset:3072 nt
    v_perm_b32 v36, v77, v73, s77
    v_perm_b32 v37, v85, v81, s77
    v_perm_b32 v38, v93, v89, s77
    v_perm_b32 v39, v101, v97, s77
    s_nop 1
    v_mfma_f32_16x16x32_bf16 v[52:55], v[36:39], v[16:19], 0
    s_xor_b32 s72, s87, 163840
    s_waitcnt vmcnt(5)
    buffer_load_dwordx4 v[152:155], v3, s[48:51], s72 offen offset:0 nt
    v_perm_b32 v32, v78, v74, s76
    v_perm_b32 v33, v86, v82, s76
    v_perm_b32 v34, v94, v90, s76
    v_perm_b32 v35, v102, v98, s76
    s_nop 1
    v_mfma_f32_16x16x32_bf16 v[40:43], v[32:35], v[56:59], v[40:43]
    s_waitcnt vmcnt(5)
    buffer_load_dwordx4 v[156:159], v3, s[48:51], s72 offen offset:1024 nt
    v_perm_b32 v36, v78, v74, s77
    v_perm_b32 v37, v86, v82, s77
    v_perm_b32 v38, v94, v90, s77
    v_perm_b32 v39, v102, v98, s77
    s_nop 1
    v_mfma_f32_16x16x32_bf16 v[44:47], v[36:39], v[56:59], v[44:47]
    s_waitcnt vmcnt(5)
    buffer_load_dwordx4 v[160:163], v3, s[48:51], s72 offen offset:2048 nt
    v_perm_b32 v32, v79, v75, s76
    v_perm_b32 v33, v87, v83, s76
    v_perm_b32 v34, v95, v91, s76
    v_perm_b32 v35, v103, v99, s76
    s_nop 1
    v_mfma_f32_16x16x32_bf16 v[48:51], v[32:35], v[56:59], v[48:51]
    s_waitcnt vmcnt(5)
    buffer_load_dwordx4 v[164:167], v3, s[48:51], s72 offen offset:3072 nt
    v_perm_b32 v36, v79, v75, s77
    v_perm_b32 v37, v87, v83, s77
    v_perm_b32 v38, v95, v91, s77
    v_perm_b32 v39, v103, v99, s77
    s_nop 1
    v_mfma_f32_16x16x32_bf16 v[52:55], v[36:39], v[56:59], v[52:55]
    s_waitcnt vmcnt(8)
    s_xor_b32 s72, s87, 196608
    s_waitcnt vmcnt(5)
    buffer_load_dwordx4 v[72:75], v3, s[48:51], s72 offen offset:0 nt
    v_perm_b32 v32, v108, v104, s76
    v_perm_b32 v33, v116, v112, s76
    v_perm_b32 v34, v124, v120, s76
    v_perm_b32 v35, v132, v128, s76
    s_nop 1
    v_mfma_f32_16x16x32_bf16 v[40:43], v[32:35], v[20:23], v[40:43]
    v_perm_b32 v36, v108, v104, s77
    v_perm_b32 v37, v116, v112, s77
    v_perm_b32 v38, v124, v120, s77
    v_perm_b32 v39, v132, v128, s77
    s_nop 1
    v_mfma_f32_16x16x32_bf16 v[44:47], v[36:39], v[20:23], v[44:47]
    s_waitcnt vmcnt(5)
    buffer_load_dwordx4 v[76:79], v3, s[48:51], s72 offen offset:1024 nt
    v_perm_b32 v32, v109, v105, s76
    v_perm_b32 v33, v117, v113, s76
    v_perm_b32 v34, v125, v121, s76
    v_perm_b32 v35, v133, v129, s76
    s_nop 1
    v_mfma_f32_16x16x32_bf16 v[48:51], v[32:35], v[20:23], v[48:51]
    v_perm_b32 v36, v109, v105, s77
    v_perm_b32 v37, v117, v113, s77
    v_perm_b32 v38, v125, v121, s77
    v_perm_b32 v39, v133, v129, s77
    s_nop 1
    v_mfma_f32_16x16x32_bf16 v[52:55], v[36:39], v[20:23], v[52:55]
    s_waitcnt vmcnt(5)
    buffer_load_dwordx4 v[80:83], v3, s[48:51], s72 offen offset:2048 nt
    v_perm_b32 v32, v110, v106, s76
    v_perm_b32 v33, v118, v114, s76
    v_perm_b32 v34, v126, v122, s76
    v_perm_b32 v35, v134, v130, s76
    s_nop 1
    v_mfma_f32_16x16x32_bf16 v[40:43], v[32:35], v[60:63], v[40:43]
    v_perm_b32 v36, v110, v106, s77
    v_perm_b32 v37, v118, v114, s77
    v_perm_b32 v38, v126, v122, s77
    v_perm_b32 v39, v134, v130, s77
    s_nop 1
    v_mfma_f32_16x16x32_bf16 v[44:47], v[36:39], v[60:63], v[44:47]
    s_waitcnt vmcnt(5)
    buffer_load_dwordx4 v[84:87], v3, s[48:51], s72 offen offset:3072 nt
    v_perm_b32 v32, v111, v107, s76
    v_perm_b32 v33, v119, v115, s76
    v_perm_b32 v34, v127, v123, s76
    v_perm_b32 v35, v135, v131, s76
    s_nop 1
    v_mfma_f32_16x16x32_bf16 v[48:51], v[32:35], v[60:63], v[48:51]
    v_perm_b32 v36, v111, v107, s77
    v_perm_b32 v37, v119, v115, s77
    v_perm_b32 v38, v127, v123, s77
    v_perm_b32 v39, v135, v131, s77
    s_nop 1
    v_mfma_f32_16x16x32_bf16 v[52:55], v[36:39], v[60:63], v[52:55]
    v_lshlrev_b32 v15, 7, v7
    s_sub_u32 s88, s7, 0
    s_cselect_b32 s88, 64, s88
    s_mul_i32 s88, s88, 2
    s_add_u32 s88, s88, s3
    s_cmp_ge_u32 s3, 2
    s_cselect_b32 s88, 64, s88
    s_bitcmp1_b32 s6, 0
    s_cselect_b32 s88, s88, 64
    s_cmp_ge_u32 s88, 32
    s_cbranch_scc1 L_noml2
    s_lshl_b32 s89, s5, 12
    s_lshr_b32 s10, s88, 2
    s_lshl_b32 s9, s10, 4
    s_add_u32 s89, s89, s9
    s_add_u32 s89, s89, 4096
    buffer_load_dwordx4 v[104:107], v15, s[52:55], s89 offen offset:0 sc1
    buffer_load_dwordx4 v[108:111], v15, s[52:55], s89 offen offset:1024 sc1
    buffer_load_dwordx4 v[112:115], v15, s[52:55], s89 offen offset:2048 sc1
    buffer_load_dwordx4 v[116:119], v15, s[52:55], s89 offen offset:3072 sc1
    v_lshlrev_b32 v0, 9, v7
    v_lshl_add_u32 v0, v8, 4, v0
    s_lshl_b32 s90, s5, 3
    s_add_u32 s90, s90, s10
    s_lshl_b32 s90, s90, 14
    s_and_b32 s9, s88, 3
    s_lshl_b32 s9, s9, 7
    s_add_u32 s90, s90, s9
    s_add_u32 s90, s90, 2097152
    s_add_u32 s91, s90, 4096
    s_add_u32 s92, s90, 8192
    s_add_u32 s93, s90, 12288
L_noml2:
    s_waitcnt vmcnt(4)
    s_xor_b32 s72, s87, 229376
    s_waitcnt vmcnt(5)
    buffer_load_dwordx4 v[88:91], v3, s[48:51], s72 offen offset:0 nt
    v_perm_b32 v32, v140, v136, s76
    v_perm_b32 v33, v148, v144, s76
    v_perm_b32 v34, v156, v152, s76
    v_perm_b32 v35, v164, v160, s76
    s_nop 1
    v_mfma_f32_16x16x32_bf16 v[40:43], v[32:35], v[24:27], v[40:43]
    v_perm_b32 v36, v140, v136, s77
    v_perm_b32 v37, v148, v144, s77
    v_perm_b32 v38, v156, v152, s77
    v_perm_b32 v39, v164, v160, s77
    s_nop 1
    v_mfma_f32_16x16x32_bf16 v[44:47], v[36:39], v[24:27], v[44:47]
    s_waitcnt vmcnt(5)
    buffer_load_dwordx4 v[92:95], v3, s[48:51], s72 offen offset:1024 nt
    v_perm_b32 v32, v141, v137, s76
    v_perm_b32 v33, v149, v145, s76
    v_perm_b32 v34, v157, v153, s76
    v_perm_b32 v35, v165, v161, s76
    s_nop 1
    v_mfma_f32_16x16x32_bf16 v[48:51], v[32:35], v[24:27], v[48:51]
    v_perm_b32 v36, v141, v137, s77
    v_perm_b32 v37, v149, v145, s77
    v_perm_b32 v38, v157, v153, s77
    v_perm_b32 v39, v165, v161, s77
    s_nop 1
    v_mfma_f32_16x16x32_bf16 v[52:55], v[36:39], v[24:27], v[52:55]
    s_waitcnt vmcnt(5)
    buffer_load_dwordx4 v[96:99], v3, s[48:51], s72 offen offset:2048 nt
    v_perm_b32 v32, v142, v138, s76
    v_perm_b32 v33, v150, v146, s76
    v_perm_b32 v34, v158, v154, s76
    v_perm_b32 v35, v166, v162, s76
    s_nop 1
    v_mfma_f32_16x16x32_bf16 v[40:43], v[32:35], v[64:67], v[40:43]
    v_perm_b32 v36, v142, v138, s77
    v_perm_b32 v37, v150, v146, s77
    v_perm_b32 v38, v158, v154, s77
    v_perm_b32 v39, v166, v162, s77
    s_nop 1
    v_mfma_f32_16x16x32_bf16 v[44:47], v[36:39], v[64:67], v[44:47]
    s_waitcnt vmcnt(5)
    buffer_load_dwordx4 v[100:103], v3, s[48:51], s72 offen offset:3072 nt
    v_perm_b32 v32, v143, v139, s76
    v_perm_b32 v33, v151, v147, s76
    v_perm_b32 v34, v159, v155, s76
    v_perm_b32 v35, v167, v163, s76
    s_nop 1
    v_mfma_f32_16x16x32_bf16 v[48:51], v[32:35], v[64:67], v[48:51]
    v_perm_b32 v36, v143, v139, s77
    v_perm_b32 v37, v151, v147, s77
    v_perm_b32 v38, v159, v155, s77
    v_perm_b32 v39, v167, v163, s77
    s_nop 1
    v_mfma_f32_16x16x32_bf16 v[52:55], v[36:39], v[64:67], v[52:55]
    s_waitcnt vmcnt(4)
    s_cmp_ge_u32 s88, 32
    s_cbranch_scc1 L_nof
    s_mov_b32 s81, 200007
    s_branch Lchk_44
Lpoll_42:
    buffer_load_dwordx4 v[104:107], v15, s[52:55], s89 offen offset:0 sc1
    buffer_load_dwordx4 v[108:111], v15, s[52:55], s89 offen offset:1024 sc1
    buffer_load_dwordx4 v[112:115], v15, s[52:55], s89 offen offset:2048 sc1
    buffer_load_dwordx4 v[116:119], v15, s[52:55], s89 offen offset:3072 sc1
    s_waitcnt vmcnt(0)
Lchk_44:
    v_xor_b32 v104, v13, v104
    v_xor_b32 v105, v13, v105
    v_xor_b32 v106, v13, v106
    v_xor_b32 v107, v13, v107
    v_xor_b32 v108, v13, v108
    v_xor_b32 v109, v13, v109
    v_xor_b32 v110, v13, v110
    v_xor_b32 v111, v13, v111
    v_xor_b32 v112, v13, v112
    v_xor_b32 v113, v13, v113
    v_xor_b32 v114, v13, v114
    v_xor_b32 v115, v13, v115
    v_xor_b32 v116, v13, v116
    v_xor_b32 v117, v13, v117
    v_xor_b32 v118, v13, v118
    v_xor_b32 v119, v13, v119
    v_or_b32 v12, v104, v105
    v_or3_b32 v12, v12, v106, v107
    v_or3_b32 v12, v12, v108, v109
    v_or3_b32 v12, v12, v110, v111
    v_or3_b32 v12, v12, v112, v113
    v_or3_b32 v12, v12, v114, v115
    v_or3_b32 v12, v12, v116, v117
    v_or3_b32 v12, v12, v118, v119
    v_and_b32 v12, s83, v12
    v_cmp_ne_u32 vcc, 0, v12
    s_cbranch_vccz Ldone_43
    s_mov_b64 exec, vcc
    s_sub_u32 s81, s81, 1
    s_cbranch_scc0 Lpoll_42
Ldone_43:
    s_mov_b64 exec, -1
    v_max3_f32 v5, v104, v108, v112
    v_max_f32 v5, v5, v116
    s_nop 1
    v_max_f32_dpp v5, v5, v5 row_ror:8 row_mask:0xf bank_mask:0xf
    v_mov_b32 v6, v5
    s_nop 1
    v_permlane16_swap_b32 v5, v6
    v_max_f32 v5, v5, v6
    v_mov_b32 v6, v5
    s_nop 1
    v_permlane32_swap_b32 v5, v6
    v_max_f32 v5, v5, v6
    v_sub_f32 v120, v104, v5
    v_mul_f32 v120, s79, v120
    v_exp_f32 v120, v120
    v_sub_f32 v121, v108, v5
    v_mul_f32 v121, s79, v121
    v_exp_f32 v121, v121
    v_sub_f32 v122, v112, v5
    v_mul_f32 v122, s79, v122
    v_exp_f32 v122, v122
    v_sub_f32 v123, v116, v5
    v_mul_f32 v123, s79, v123
    v_exp_f32 v123, v123
    v_mul_f32 v5, v120, v105
    v_fmac_f32 v5, v121, v109
    v_fmac_f32 v5, v122, v113
    v_fmac_f32 v5, v123, v117
    s_nop 1
    v_add_f32_dpp v5, v5, v5 row_ror:8 row_mask:0xf bank_mask:0xf
    v_mov_b32 v6, v5
    s_nop 1
    v_permlane16_swap_b32 v5, v6
    v_add_f32 v5, v5, v6
    v_mov_b32 v6, v5
    s_nop 1
    v_permlane32_swap_b32 v5, v6
    v_add_f32 v5, v5, v6
    v_rcp_f32 v5, v5
    s_nop 0
    v_mul_f32 v120, v120, v5
    v_mul_f32 v121, v121, v5
    v_mul_f32 v122, v122, v5
    v_mul_f32 v123, v123, v5
    s_lshl_b32 s89, s5, 5
    s_add_u32 s89, s89, s88
    s_mul_i32 s89, s89, 128
    s_add_u32 s89, s89, 5242880
L_nof:
    v_perm_b32 v136, v76, v72, s76
    v_perm_b32 v140, v76, v72, s77
    v_perm_b32 v144, v77, v73, s76
    v_perm_b32 v148, v77, v73, s77
    v_perm_b32 v152, v78, v74, s76
    v_perm_b32 v156, v78, v74, s77
    v_perm_b32 v160, v79, v75, s76
    v_perm_b32 v164, v79, v75, s77
    v_perm_b32 v137, v84, v80, s76
    v_perm_b32 v141, v84, v80, s77
    v_perm_b32 v145, v85, v81, s76
    v_perm_b32 v149, v85, v81, s77
    v_perm_b32 v153, v86, v82, s76
    v_perm_b32 v157, v86, v82, s77
    v_perm_b32 v161, v87, v83, s76
    v_perm_b32 v165, v87, v83, s77
    s_bitcmp1_b32 s6, 0
    s_cbranch_scc1 L_nw1p
    v_mov_b32 v4, 111616
    v_mov_b32 v5, 1
    s_mov_b64 exec, 1
    ds_add_rtn_u32 v5, v4, v5 offset:16
    s_mov_b64 exec, -1
    s_waitcnt lgkmcnt(0)
    v_readfirstlane_b32 s21, v5
    s_nop 0
    s_cmp_ge_u32 s21, s20
    s_cbranch_scc1 L_nw1p
    s_lshl_b32 m0, s21, 10
    s_mul_i32 s9, s21, s19
    s_add_u32 s9, s9, s18
    s_lshr_b32 s22, s21, 1
    s_and_b32 s22, s22, s16
    s_lshl_b32 s22, s22, 5
    s_lshr_b32 s21, s21, s17
    s_and_b32 s21, s21, 1
    s_lshl_b32 s21, s21, 7
    s_or_b32 s22, s22, s21
    v_xor_b32 v4, s22, v2
    buffer_load_dwordx4 v4, s[64:67], s9 offen nt lds
    v_mov_b32 v4, 111616
    v_mov_b32 v5, 1
    s_mov_b64 exec, 1
    ds_add_rtn_u32 v5, v4, v5 offset:16
    s_mov_b64 exec, -1
    s_waitcnt lgkmcnt(0)
    v_readfirstlane_b32 s21, v5
    s_nop 0
    s_cmp_ge_u32 s21, s20
    s_cbranch_scc1 L_nw1p
    s_lshl_b32 m0, s21, 10
    s_mul_i32 s9, s21, s19
    s_add_u32 s9, s9, s18
    s_lshr_b32 s22, s21, 1
    s_and_b32 s22, s22, s16
    s_lshl_b32 s22, s22, 5
    s_lshr_b32 s21, s21, s17
    s_and_b32 s21, s21, 1
    s_lshl_b32 s21, s21, 7
    s_or_b32 s22, s22, s21
    v_xor_b32 v4, s22, v2
    buffer_load_dwordx4 v4, s[64:67], s9 offen nt lds
    v_mov_b32 v4, 111616
    v_mov_b32 v5, 1
    s_mov_b64 exec, 1
    ds_add_rtn_u32 v5, v4, v5 offset:16
    s_mov_b64 exec, -1
    s_waitcnt lgkmcnt(0)
    v_readfirstlane_b32 s21, v5
    s_nop 0
    s_cmp_ge_u32 s21, s20
    s_cbranch_scc1 L_nw1p
    s_lshl_b32 m0, s21, 10
    s_mul_i32 s9, s21, s19
    s_add_u32 s9, s9, s18
    s_lshr_b32 s22, s21, 1
    s_and_b32 s22, s22, s16
    s_lshl_b32 s22, s22, 5
    s_lshr_b32 s21, s21, s17
    s_and_b32 s21, s21, 1
    s_lshl_b32 s21, s21, 7
    s_or_b32 s22, s22, s21
    v_xor_b32 v4, s22, v2
    buffer_load_dwordx4 v4, s[64:67], s9 offen nt lds
    s_waitcnt vmcnt(5)
    v_perm_b32 v138, v92, v88, s76
    v_perm_b32 v142, v92, v88, s77
    v_perm_b32 v146, v93, v89, s76
    v_perm_b32 v150, v93, v89, s77
    v_perm_b32 v154, v94, v90, s76
    v_perm_b32 v158, v94, v90, s77
    v_perm_b32 v162, v95, v91, s76
    v_perm_b32 v166, v95, v91, s77
    s_waitcnt vmcnt(3)
    s_branch L_w1pd
L_nw1p:
    s_waitcnt vmcnt(2)
    v_perm_b32 v138, v92, v88, s76
    v_perm_b32 v142, v92, v88, s77
    v_perm_b32 v146, v93, v89, s76
    v_perm_b32 v150, v93, v89, s77
    v_perm_b32 v154, v94, v90, s76
    v_perm_b32 v158, v94, v90, s77
    v_perm_b32 v162, v95, v91, s76
    v_perm_b32 v166, v95, v91, s77
    s_waitcnt vmcnt(0)
L_w1pd:
    v_perm_b32 v139, v100, v96, s76
    v_perm_b32 v143, v100, v96, s77
    v_perm_b32 v147, v101, v97, s76
    v_perm_b32 v151, v101, v97, s77
    v_perm_b32 v155, v102, v98, s76
    v_perm_b32 v159, v102, v98, s77
    v_perm_b32 v163, v103, v99, s76
    v_perm_b32 v167, v103, v99, s77
    v_mfma_f32_16x16x32_bf16 v[40:43], v[136:139], v[28:31], v[40:43]
    v_mfma_f32_16x16x32_bf16 v[44:47], v[140:143], v[28:31], v[44:47]
    v_mfma_f32_16x16x32_bf16 v[48:51], v[144:147], v[28:31], v[48:51]
    v_mfma_f32_16x16x32_bf16 v[52:55], v[148:151], v[28:31], v[52:55]
    v_mfma_f32_16x16x32_bf16 v[40:43], v[152:155], v[68:71], v[40:43]
    v_mfma_f32_16x16x32_bf16 v[44:47], v[156:159], v[68:71], v[44:47]
    v_mfma_f32_16x16x32_bf16 v[48:51], v[160:163], v[68:71], v[48:51]
    v_mfma_f32_16x16x32_bf16 v[52:55], v[164:167], v[68:71], v[52:55]
    s_nop 4
    ds_write_b128 v9, v[40:43] offset:0
    ds_write_b128 v9, v[44:47] offset:64
    ds_write_b128 v9, v[48:51] offset:128
    ds_write_b128 v9, v[52:55] offset:192
    s_waitcnt lgkmcnt(0)
    s_barrier
    ds_read_b128 v[16:19], v10 offset:0
    ds_read_b128 v[20:23], v10 offset:4224
    ds_read_b128 v[24:27], v10 offset:8448
    ds_read_b128 v[28:31], v10 offset:12672
    s_waitcnt lgkmcnt(0)
    v_pk_add_f32 v[16:17], v[16:17], v[20:21]
    v_pk_add_f32 v[18:19], v[18:19], v[22:23]
    v_pk_add_f32 v[24:25], v[24:25], v[28:29]
    v_pk_add_f32 v[26:27], v[26:27], v[30:31]
    v_pk_add_f32 v[20:21], v[16:17], v[24:25]
    v_pk_add_f32 v[22:23], v[18:19], v[26:27]
    v_pk_add_f32 v[16:17], v[16:17], v[24:25]
    v_pk_add_f32 v[18:19], v[18:19], v[26:27]
    s_nop 0
    v_permlane32_swap_b32 v16, v20
    v_permlane32_swap_b32 v17, v21
    v_permlane32_swap_b32 v18, v22
    v_permlane32_swap_b32 v19, v23
    v_pk_add_f32 v[16:17], v[16:17], v[20:21]
    v_pk_add_f32 v[18:19], v[18:19], v[22:23]
    v_bfi_b32 v16, s83, v13, v16
    v_bfi_b32 v17, s83, v13, v17
    v_bfi_b32 v18, s83, v13, v18
    v_bfi_b32 v19, s83, v13, v19
    s_mov_b32 exec_hi, 0
    s_cmp_eq_u32 s101, 1
    s_cbranch_scc1 Lsg_45
    buffer_store_dwordx4 v[16:19], v11, s[52:55], s11 offen sc1
    s_branch Lsgd_46
Lsg_45:
    buffer_store_dwordx4 v[16:19], v11, s[52:55], s11 offen
Lsgd_46:
    s_mov_b64 exec, -1
    s_cmp_ge_u32 s88, 32
    s_cbranch_scc1 Lnoh1a_47
    s_mov_b32 s81, 200007
Lpoll_48:
    buffer_load_dwordx4 v[104:107], v0, s[52:55], s90 offen sc1
    buffer_load_dwordx4 v[108:111], v0, s[52:55], s91 offen sc1
    buffer_load_dwordx4 v[112:115], v0, s[52:55], s92 offen sc1
    buffer_load_dwordx4 v[116:119], v0, s[52:55], s93 offen sc1
Lchk_50:
    s_waitcnt vmcnt(0)
    v_xor_b32 v104, v13, v104
    v_xor_b32 v105, v13, v105
    v_xor_b32 v106, v13, v106
    v_xor_b32 v107, v13, v107
    v_xor_b32 v108, v13, v108
    v_xor_b32 v109, v13, v109
    v_xor_b32 v110, v13, v110
    v_xor_b32 v111, v13, v111
    v_xor_b32 v112, v13, v112
    v_xor_b32 v113, v13, v113
    v_xor_b32 v114, v13, v114
    v_xor_b32 v115, v13, v115
    v_xor_b32 v116, v13, v116
    v_xor_b32 v117, v13, v117
    v_xor_b32 v118, v13, v118
    v_xor_b32 v119, v13, v119
    v_or_b32 v12, v104, v105
    v_or3_b32 v12, v12, v106, v107
    v_or3_b32 v12, v12, v108, v109
    v_or3_b32 v12, v12, v110, v111
    v_or3_b32 v12, v12, v112, v113
    v_or3_b32 v12, v12, v114, v115
    v_or3_b32 v12, v12, v116, v117
    v_or3_b32 v12, v12, v118, v119
    v_and_b32 v12, s83, v12
    v_cmp_ne_u32 vcc, 0, v12
    s_cbranch_vccz Ldone_49
    s_mov_b64 exec, vcc
    s_sub_u32 s81, s81, 1
    s_cbranch_scc0 Lpoll_48
Ldone_49:
    s_mov_b64 exec, -1
    v_pk_mul_f32 v[104:105], v[104:105], v[120:121] op_sel:[0,0] op_sel_hi:[1,0]
    v_pk_mul_f32 v[106:107], v[106:107], v[120:121] op_sel:[0,0] op_sel_hi:[1,0]
    v_pk_mul_f32 v[112:113], v[112:113], v[122:123] op_sel:[0,0] op_sel_hi:[1,0]
    v_pk_mul_f32 v[114:115], v[114:115], v[122:123] op_sel:[0,0] op_sel_hi:[1,0]
    v_pk_fma_f32 v[104:105], v[108:109], v[120:121], v[104:105] op_sel:[0,1,0] op_sel_hi:[1,1,1]
    v_pk_fma_f32 v[106:107], v[110:111], v[120:121], v[106:107] op_sel:[0,1,0] op_sel_hi:[1,1,1]
    v_pk_fma_f32 v[112:113], v[116:117], v[122:123], v[112:113] op_sel:[0,1,0] op_sel_hi:[1,1,1]
    v_pk_fma_f32 v[114:115], v[118:119], v[122:123], v[114:115] op_sel:[0,1,0] op_sel_hi:[1,1,1]
    v_pk_add_f32 v[104:105], v[104:105], v[112:113]
    v_pk_add_f32 v[106:107], v[106:107], v[114:115]
    s_nop 0
    v_permlane32_swap_b32 v104, v105
    v_permlane32_swap_b32 v106, v107
    v_add_f32 v104, v104, v105
    v_add_f32 v106, v106, v107
    s_nop 1
    v_permlane16_swap_b32 v104, v106
    v_add_f32 v104, v104, v106
    s_nop 1
    v_add_f32_dpp v104, v104, v104 row_ror:8 row_mask:0xf bank_mask:0xf
    v_cvt_pk_bf16_f32 v104, v104, v104
    v_bfi_b32 v104, s78, v104, v13
    v_mov_b32 v105, v104
    s_nop 1
    v_permlane32_swap_b32 v104, v105
    v_mov_b32 v106, v104
    v_mov_b32 v107, v105
    s_nop 0
    v_permlane16_swap_b32 v104, v106
    v_permlane16_swap_b32 v105, v107
    s_mov_b64 exec, 0xff
    buffer_store_dwordx4 v[104:107], v3, s[52:55], s89 offen sc1
    s_mov_b64 exec, -1
Lnoh1a_47:
    s_bitcmp1_b32 s6, 0
    s_cbranch_scc1 L_tailB
Lca_51:
    v_mov_b32 v4, 111616
    v_mov_b32 v5, 1
    s_mov_b64 exec, 1
    ds_add_rtn_u32 v5, v4, v5 offset:16
    s_mov_b64 exec, -1
    s_waitcnt lgkmcnt(0)
    v_readfirstlane_b32 s21, v5
    s_nop 0
    s_cmp_ge_u32 s21, s20
    s_cbranch_scc1 Lcad_52
    s_lshl_b32 m0, s21, 10
    s_mul_i32 s9, s21, s19
    s_add_u32 s9, s9, s18
    s_lshr_b32 s22, s21, 1
    s_and_b32 s22, s22, s16
    s_lshl_b32 s22, s22, 5
    s_lshr_b32 s21, s21, s17
    s_and_b32 s21, s21, 1
    s_lshl_b32 s21, s21, 7
    s_or_b32 s22, s22, s21
    v_xor_b32 v4, s22, v2
    buffer_load_dwordx4 v4, s[64:67], s9 offen nt lds
    s_branch Lca_51
Lcad_52:
    v_lshrrev_b32 v7, 4, v1
    v_and_b32 v9, 15, v1
    v_lshrrev_b32 v10, 5, v1
    v_and_b32 v5, 1, v7
    v_lshlrev_b32 v20, 6, v5
    v_bfe_u32 v6, v1, 2, 2
    v_lshl_add_u32 v20, v6, 3, v20
    v_add_u32 v20, v20, v10
    v_lshlrev_b32 v20, 8, v20
    v_and_b32 v6, 3, v1
    v_lshl_add_u32 v20, v6, 3, v20
    s_lshl_b32 s9, s3, 5
    v_add_u32 v20, s9, v20
    v_bfe_u32 v6, v1, 2, 3
    v_lshlrev_b32 v6, 5, v6
    v_xor_b32 v20, v20, v6
    v_lshlrev_b32 v28, 12, v5
    v_lshl_add_u32 v28, v9, 5, v28
    v_lshl_add_u32 v28, v10, 4, v28
    s_lshl_b32 s14, s86, 13
    s_lshl_b32 s9, s3, 9
    s_add_u32 s14, s14, s9
    s_add_u32 s14, s14, 3145728
    v_and_b32 v11, 31, v1
    v_lshlrev_b32 v21, 14, v10
    v_lshl_add_u32 v21, v11, 4, v21
    s_lshl_b32 s74, s7, 10
    s_add_u32 s74, s74, 5242880
    s_mul_i32 s9, s3, 1152
    s_add_u32 s9, s9, 65536
    v_mul_u32_u24 v22, 576, v10
    v_lshl_add_u32 v22, v11, 3, v22
    v_add_u32 v22, s9, v22
    v_and_b32 v5, 1, v1
    v_mul_u32_u24 v23, 576, v5
    v_lshl_add_u32 v23, v7, 4, v23
    v_add_u32 v23, s9, v23
    v_lshlrev_b32 v24, 12, v5
    v_lshl_add_u32 v24, v7, 4, v24
    s_lshl_b32 s73, s7, 13
    s_lshl_b32 s9, s5, 9
    s_add_u32 s73, s73, s9
    s_lshl_b32 s9, s3, 6
    s_add_u32 s73, s73, s9
    s_add_u32 s73, s73, 1048576
    s_mov_b32 s56, s32
    s_mov_b32 s57, s33
    s_mov_b32 s58, 7340032
    s_mov_b32 s59, 0x20000
    s_mov_b32 s60, s30
    s_mov_b32 s61, s31
    s_mov_b32 s62, 7168
    s_mov_b32 s63, 0x20000
    v_lshlrev_b32 v30, 14, v7
    v_lshl_add_u32 v30, v9, 4, v30
    s_lshl_b32 s15, s86, 16
    s_lshl_b32 s9, s3, 8
    s_add_u32 s15, s15, s9
    s_cmp_ge_u32 s7, 8
    s_cbranch_scc1 L_nw2p
    s_add_u32 s9, s15, 14336
    buffer_load_dwordx4 v[164:167], v30, s[56:59], s9 offen nt
L_nw2p:
    v_bfe_u32 v4, v1, 4, 1
    v_lshrrev_b32 v5, 5, v1
    v_lshl_or_b32 v4, v4, 1, v5
    v_and_b32 v6, 7, v1
    v_lshl_add_u32 v31, v6, 2, v4
    v_lshlrev_b32 v31, 1, v31
    v_bfe_u32 v8, v1, 3, 1
    v_lshl_add_u32 v26, v8, 6, v31
    s_lshl_b32 s9, s3, 7
    s_add_u32 s9, s9, 110592
    v_add_u32 v26, s9, v26
    v_bfe_u32 v5, v1, 2, 1
    v_lshlrev_b32 v27, 6, v5
    v_lshl_add_u32 v27, v7, 4, v27
    v_add_u32 v27, s9, v27
    v_lshlrev_b32 v25, 10, v7
    v_lshl_add_u32 v25, v8, 9, v25
    v_lshl_add_u32 v25, v6, 4, v25
    s_and_b32 s9, s86, 3
    s_lshl_b32 s89, s9, 7
    s_andn2_b32 s10, s86, 3
    s_lshl_b32 s10, s10, 10
    s_add_u32 s89, s89, s10
    s_add_u32 s89, s89, 917504
    s_lshr_b32 s12, s7, 2
    s_and_b32 s13, s7, 3
    s_lshl_b32 s13, s13, 5
    s_lshl_b32 s9, s5, 7
    s_add_u32 s13, s13, s9
    s_lshl_b32 s75, s12, 12
    s_lshl_b32 s9, s13, 2
    s_add_u32 s75, s75, s9
    v_lshrrev_b32 v6, 3, v1
    v_and_b32 v8, 7, v1
    v_lshl_add_u32 v11, v8, 2, v4
    v_lshlrev_b32 v5, 2, v11
    v_add_u32 v2, 111744, v5
    s_mul_i32 s88, s75, 33
    s_add_u32 s88, s88, 1572864
    v_lshlrev_b32 v0, 13, v6
    v_lshl_add_u32 v0, v8, 4, v0
    ds_read_b32 v136, v2 offset:384
    ds_read_b32 v5, v2 offset:512
    ds_read_b32 v6, v2 offset:256
    ds_read_b32 v15, v2 offset:128
    ds_read_b32 v137, v2
    ds_read_b32 v138, v2 offset:640
    v_mov_b32 v144, v3
    s_mov_b32 s9, 2064
    v_writelane_b32 v144, s9, 8
    s_mov_b32 s9, 2048
    v_writelane_b32 v144, s9, 16
    v_mov_b32 v40, 0
    v_mov_b32 v41, 0
    v_mov_b32 v42, 0
    v_mov_b32 v43, 0
    v_mov_b32 v44, 0
    v_mov_b32 v45, 0
    v_mov_b32 v46, 0
    v_mov_b32 v47, 0
    v_mov_b32 v48, 0
    v_mov_b32 v49, 0
    v_mov_b32 v50, 0
    v_mov_b32 v51, 0
    v_mov_b32 v52, 0
    v_mov_b32 v53, 0
    v_mov_b32 v54, 0
    v_mov_b32 v55, 0
    v_mov_b32 v56, 0
    v_mov_b32 v57, 0
    v_mov_b32 v58, 0
    v_mov_b32 v59, 0
    v_mov_b32 v60, 0
    v_mov_b32 v61, 0
    v_mov_b32 v62, 0
    v_mov_b32 v63, 0
    v_mov_b32 v64, 0
    v_mov_b32 v65, 0
    v_mov_b32 v66, 0
    v_mov_b32 v67, 0
    v_mov_b32 v68, 0
    v_mov_b32 v69, 0
    v_mov_b32 v70, 0
    v_mov_b32 v71, 0
    v_bfe_u32 v21, v1, 3, 1
    v_mul_u32_u24 v22, 576, v21
    v_lshlrev_b32 v21, 14, v21
    v_lshl_add_u32 v21, v8, 4, v21
    v_lshl_add_u32 v22, v8, 3, v22
    s_lshl_b32 s9, s3, 6
    s_add_u32 s9, s9, 104448
    v_add_u32 v22, s9, v22
    v_and_b32 v23, 1, v1
    v_mul_u32_u24 v23, 576, v23
    v_lshl_add_u32 v23, v7, 4, v23
    v_add_u32 v23, 104448, v23
    s_lshl_b32 s9, s3, 7
    s_add_u32 s10, s74, s9
    s_add_u32 s92, s42, s10
    s_addc_u32 s93, s43, 0
    s_mov_b32 s81, 2000
Lsg_53:
    s_load_dword s16, s[92:93], 0 glc
    s_load_dword s17, s[92:93], 16384 glc
    s_waitcnt lgkmcnt(0)
    s_xor_b32 s9, s16, s8
    s_xor_b32 s17, s17, s8
    s_or_b32 s9, s9, s17
    s_and_b32 s9, s9, s83
    s_cbranch_scc0 Lsgd_54
    s_sleep 2
    s_sub_u32 s81, s81, 1
    s_cbranch_scc0 Lsg_53
Lsgd_54:
    s_mov_b64 exec, 0xffff
    s_mov_b32 s81, 200007
Lpoll_55:
    buffer_load_dwordx4 v[32:35], v21, s[52:55], s10 offen sc1
Lchk_57:
    s_waitcnt vmcnt(0)
    v_xor_b32 v32, v13, v32
    v_xor_b32 v33, v13, v33
    v_xor_b32 v34, v13, v34
    v_xor_b32 v35, v13, v35
    v_or_b32 v12, v32, v33
    v_or3_b32 v12, v12, v34, v35
    v_and_b32 v12, s83, v12
    v_cmp_ne_u32 vcc, 0, v12
    s_cbranch_vccz Ldone_56
    s_mov_b64 exec, vcc
    s_sub_u32 s81, s81, 1
    s_cbranch_scc0 Lpoll_55
Ldone_56:
    s_mov_b64 exec, -1
    v_perm_b32 v16, v33, v32, s77
    v_perm_b32 v17, v35, v34, s77
    s_mov_b64 exec, 0xffff
    ds_write_b64 v22, v[16:17]
    s_mov_b64 exec, -1
    s_waitcnt lgkmcnt(0)
    s_barrier
    ds_read_b64_tr_b16 v[72:73], v20 offset:0
    ds_read_b64_tr_b16 v[74:75], v20 offset:8192
    ds_read_b128 v[104:107], v23 offset:0
    ds_read_b64_tr_b16 v[76:77], v20 offset:512
    ds_read_b64_tr_b16 v[78:79], v20 offset:8704
    ds_read_b128 v[108:111], v23 offset:64
    ds_read_b64_tr_b16 v[80:81], v20 offset:1024
    ds_read_b64_tr_b16 v[82:83], v20 offset:9216
    ds_read_b128 v[112:115], v23 offset:128
    ds_read_b64_tr_b16 v[84:85], v20 offset:1536
    ds_read_b64_tr_b16 v[86:87], v20 offset:9728
    ds_read_b128 v[116:119], v23 offset:192
    ds_read_b64_tr_b16 v[88:89], v20 offset:32768
    ds_read_b64_tr_b16 v[90:91], v20 offset:40960
    ds_read_b128 v[120:123], v23 offset:256
    ds_read_b64_tr_b16 v[92:93], v20 offset:33280
    ds_read_b64_tr_b16 v[94:95], v20 offset:41472
    ds_read_b128 v[124:127], v23 offset:320
    ds_read_b64_tr_b16 v[96:97], v20 offset:33792
    ds_read_b64_tr_b16 v[98:99], v20 offset:41984
    ds_read_b128 v[128:131], v23 offset:384
    ds_read_b64_tr_b16 v[100:101], v20 offset:34304
    ds_read_b64_tr_b16 v[102:103], v20 offset:42496
    ds_read_b128 v[132:135], v23 offset:448
    s_waitcnt lgkmcnt(15)
    v_mfma_f32_16x16x32_bf16 v[32:35], v[72:75], v[104:107], 0
    s_waitcnt lgkmcnt(15)
    v_mfma_f32_16x16x32_bf16 v[32:35], v[76:79], v[108:111], v[32:35]
    s_waitcnt lgkmcnt(15)
    v_mfma_f32_16x16x32_bf16 v[32:35], v[80:83], v[112:115], v[32:35]
    s_waitcnt lgkmcnt(12)
    v_mfma_f32_16x16x32_bf16 v[32:35], v[84:87], v[116:119], v[32:35]
    s_waitcnt lgkmcnt(9)
    v_mfma_f32_16x16x32_bf16 v[32:35], v[88:91], v[120:123], v[32:35]
    s_waitcnt lgkmcnt(6)
    v_mfma_f32_16x16x32_bf16 v[32:35], v[92:95], v[124:127], v[32:35]
    s_waitcnt lgkmcnt(3)
    v_mfma_f32_16x16x32_bf16 v[32:35], v[96:99], v[128:131], v[32:35]
    s_waitcnt lgkmcnt(0)
    v_mfma_f32_16x16x32_bf16 v[32:35], v[100:103], v[132:135], v[32:35]
    s_mov_b32 exec_lo, 0x00030003
    s_mov_b32 exec_hi, 0x00030003
    s_nop 5
    v_bfi_b32 v32, s83, v13, v32
    v_bfi_b32 v33, s83, v13, v33
    v_bfi_b32 v34, s83, v13, v34
    v_bfi_b32 v35, s83, v13, v35
    s_cmp_eq_u32 s101, 1
    s_cbranch_scc1 Lsg_58
    buffer_store_dwordx4 v[32:35], v24, s[52:55], s73 offen sc1
    s_branch Lsgd_59
Lsg_58:
    buffer_store_dwordx4 v[32:35], v24, s[52:55], s73 offen
Lsgd_59:
    s_mov_b64 exec, -1
    s_cmp_ge_u32 s86, 112
    s_cbranch_scc1 L_fin
    s_cmp_ge_u32 s7, 8
    s_cbranch_scc1 L_noh2
    s_cmp_lg_u32 s3, 7
    s_cbranch_scc1 L_h2d
    s_add_u32 s10, s75, 1048576
    s_add_u32 s11, s75, 1114112
    s_mov_b32 s94, 0xff00ff00
    s_mov_b32 s95, 0xff00ff00
    v_cndmask_b32 v81, v138, v137, s[94:95]
    v_mov_b32 v143, 0
    s_mov_b32 s81, 200007
Lpoll_60:
    buffer_load_dwordx4 v[84:87], v0, s[52:55], s10 offen sc1
    buffer_load_dwordx4 v[88:91], v0, s[52:55], s11 offen sc1
Lchk_62:
    s_waitcnt vmcnt(0)
    v_xor_b32 v84, v13, v84
    v_xor_b32 v85, v13, v85
    v_xor_b32 v86, v13, v86
    v_xor_b32 v87, v13, v87
    v_xor_b32 v88, v13, v88
    v_xor_b32 v89, v13, v89
    v_xor_b32 v90, v13, v90
    v_xor_b32 v91, v13, v91
    v_or_b32 v12, v84, v85
    v_or3_b32 v12, v12, v86, v87
    v_or3_b32 v12, v12, v88, v89
    v_or3_b32 v12, v12, v90, v91
    v_and_b32 v12, s83, v12
    v_cmp_ne_u32 vcc, 0, v12
    s_cbranch_vccz Ldone_61
    s_mov_b64 exec, vcc
    s_sub_u32 s81, s81, 1
    s_cbranch_scc0 Lpoll_60
Ldone_61:
    s_mov_b64 exec, -1
    v_pk_add_f32 v[84:85], v[84:85], v[88:89]
    v_pk_add_f32 v[86:87], v[86:87], v[90:91]
    s_nop 0
    v_permlane32_swap_b32 v84, v85
    v_permlane32_swap_b32 v86, v87
    v_add_f32 v84, v84, v85
    v_add_f32 v86, v86, v87
    s_nop 1
    v_permlane16_swap_b32 v84, v86
    v_add_f32 v84, v84, v86
    s_nop 1
    v_add_f32_dpp v84, v84, v84 row_ror:8 row_mask:0xf bank_mask:0xf
    v_cvt_pk_bf16_f32 v84, v84, v84
    v_lshlrev_b32 v84, 16, v84
    v_mul_f32 v84, v136, v84
    v_cvt_pk_bf16_f32 v84, v84, v84
    v_lshlrev_b32 v84, 16, v84
    v_add_f32 v84, v5, v84
    v_cvt_pk_bf16_f32 v5, v84, v84
    v_lshlrev_b32 v5, 16, v5
    v_mul_f32 v83, v5, v138
    v_or_b32 v84, v13, v5
    v_cndmask_b32 v82, v5, v138, s[94:95]
    v_cndmask_b32 v80, v5, v83, s[94:95]
    v_cndmask_b32 v83, 1.0, v83, s[94:95]
    v_mul_f32 v141, v80, v82
    v_mul_f32 v142, v80, v81
    v_mul_f32 v140, v80, v83
    v_mov_b32 v85, v84
    s_nop 1
    v_permlane32_swap_b32 v84, v85
    v_mov_b32 v86, v84
    v_mov_b32 v87, v85
    s_nop 0
    v_permlane16_swap_b32 v84, v86
    v_permlane16_swap_b32 v85, v87
    v_permlane32_swap_b32 v140, v141
    v_permlane32_swap_b32 v142, v143
    v_add_f32 v140, v140, v141
    v_add_f32 v142, v142, v143
    s_nop 1
    v_permlane16_swap_b32 v140, v142
    v_add_f32 v140, v140, v142
    s_nop 1
    v_add_f32_dpp v140, v140, v140 quad_perm:[1,0,3,2] row_mask:0xf bank_mask:0xf
    s_nop 1
    v_add_f32_dpp v140, v140, v140 quad_perm:[2,3,0,1] row_mask:0xf bank_mask:0xf
    s_nop 1
    v_add_f32_dpp v140, v140, v140 row_half_mirror row_mask:0xf bank_mask:0xf
    v_mov_b32 v141, v140
    s_nop 1
    v_permlane32_swap_b32 v140, v141
    v_mov_b32 v142, v140
    v_mov_b32 v143, v141
    s_nop 0
    v_permlane16_swap_b32 v140, v142
    v_permlane16_swap_b32 v141, v143
    v_mov_b32 v143, s82
    s_mov_b64 exec, 0xff
    v_mov_b32 v140, v84
    v_mov_b32 v141, v85
    v_mov_b32 v142, v86
    v_mov_b32 v143, v87
    s_mov_b64 exec, 0x101ff
    buffer_store_dwordx4 v[140:143], v144, s[52:55], s88 offen sc1
    s_mov_b64 exec, -1
    s_lshl_b32 s10, s5, 7
    s_lshl_b32 s9, s7, 4
    s_add_u32 s10, s10, s9
    s_add_u32 s10, s10, 589824
    s_mov_b64 exec, 1
    s_cmp_eq_u32 s101, 1
    s_cbranch_scc1 Lsg_63
    buffer_store_dwordx4 v[84:87], v3, s[52:55], s10 offen sc1
    s_branch Lsgd_64
Lsg_63:
    buffer_store_dwordx4 v[84:87], v3, s[52:55], s10 offen
Lsgd_64:
    s_mov_b64 exec, -1
    s_cmp_lg_u32 s2, 0
    s_cbranch_scc1 L_h2d
    v_mov_b32 v98, s82
    v_mov_b32 v99, 0
    s_mov_b64 exec, 1
    buffer_store_dword v98, v99, s[52:55], 0 offen offset:0 sc1
    s_mov_b64 exec, -1
    s_branch L_h2d
L_noh2:
L_h2d:
    s_barrier
    s_add_u32 s9, s15, 0
    buffer_load_dwordx4 v[136:139], v30, s[56:59], s9 offen nt
    s_add_u32 s9, s15, 2048
    buffer_load_dwordx4 v[140:143], v30, s[56:59], s9 offen nt
    s_add_u32 s9, s15, 4096
    buffer_load_dwordx4 v[144:147], v30, s[56:59], s9 offen nt
    s_add_u32 s9, s15, 6144
    buffer_load_dwordx4 v[148:151], v30, s[56:59], s9 offen nt
    s_add_u32 s9, s15, 8192
    buffer_load_dwordx4 v[152:155], v30, s[56:59], s9 offen nt
    s_add_u32 s9, s15, 10240
    buffer_load_dwordx4 v[156:159], v30, s[56:59], s9 offen nt
    s_add_u32 s9, s15, 12288
    buffer_load_dwordx4 v[160:163], v30, s[56:59], s9 offen nt
    s_cmp_lt_u32 s7, 8
    s_cbranch_scc1 L_w2d
    s_add_u32 s9, s15, 14336
    buffer_load_dwordx4 v[164:167], v30, s[56:59], s9 offen nt
L_w2d:
    s_lshl_b32 s9, s86, 6
    buffer_load_ushort v29, v31, s[60:63], s9 offen
    s_waitcnt vmcnt(0)
    buffer_load_dwordx4 v[32:35], v25, s[52:55], s89 offen sc1
    v_perm_b32 v104, v140, v136, s76
    v_perm_b32 v105, v148, v144, s76
    v_perm_b32 v106, v156, v152, s76
    v_perm_b32 v107, v164, v160, s76
    v_perm_b32 v108, v140, v136, s77
    v_perm_b32 v109, v148, v144, s77
    v_perm_b32 v110, v156, v152, s77
    v_perm_b32 v111, v164, v160, s77
    v_perm_b32 v112, v141, v137, s76
    v_perm_b32 v113, v149, v145, s76
    v_perm_b32 v114, v157, v153, s76
    v_perm_b32 v115, v165, v161, s76
    v_perm_b32 v116, v141, v137, s77
    v_perm_b32 v117, v149, v145, s77
    v_perm_b32 v118, v157, v153, s77
    v_perm_b32 v119, v165, v161, s77
    v_perm_b32 v120, v142, v138, s76
    v_perm_b32 v121, v150, v146, s76
    v_perm_b32 v122, v158, v154, s76
    v_perm_b32 v123, v166, v162, s76
    v_perm_b32 v124, v142, v138, s77
    v_perm_b32 v125, v150, v146, s77
    v_perm_b32 v126, v158, v154, s77
    v_perm_b32 v127, v166, v162, s77
    v_perm_b32 v128, v143, v139, s76
    v_perm_b32 v129, v151, v147, s76
    v_perm_b32 v130, v159, v155, s76
    v_perm_b32 v131, v167, v163, s76
    v_perm_b32 v132, v143, v139, s77
    v_perm_b32 v133, v151, v147, s77
    v_perm_b32 v134, v159, v155, s77
    v_perm_b32 v135, v167, v163, s77
    v_lshlrev_b32 v29, 16, v29
    s_mov_b32 s81, 200007
    s_branch Lchk_67
Lpoll_65:
    buffer_load_dwordx4 v[32:35], v25, s[52:55], s89 offen sc1
Lchk_67:
    s_waitcnt vmcnt(0)
    v_xor_b32 v32, v13, v32
    v_xor_b32 v33, v13, v33
    v_xor_b32 v34, v13, v34
    v_xor_b32 v35, v13, v35
    v_or_b32 v12, v32, v33
    v_or3_b32 v12, v12, v34, v35
    v_and_b32 v12, s83, v12
    v_cmp_ne_u32 vcc, 0, v12
    s_cbranch_vccz Ldone_66
    s_mov_b64 exec, vcc
    s_sub_u32 s81, s81, 1
    s_cbranch_scc0 Lpoll_65
Ldone_66:
    s_mov_b64 exec, -1
    v_permlane32_swap_b32 v32, v33
    v_permlane32_swap_b32 v34, v35
    v_add_f32 v32, v32, v33
    v_add_f32 v34, v34, v35
    s_nop 1
    v_permlane16_swap_b32 v32, v34
    v_add_f32 v32, v32, v34
    v_cvt_pk_bf16_f32 v136, v32, v32
    v_lshlrev_b32 v136, 16, v136
    v_add_f32 v136, v136, v29
    v_cvt_pk_bf16_f32 v136, v136, v136
    v_lshlrev_b32 v136, 16, v136
    v_mul_f32 v137, v136, v136
    v_mul_f32 v137, 0x3d372713, v137
    v_fma_f32 v137, v137, v136, v136
    v_mul_f32 v137, 0xc0135761, v137
    v_exp_f32 v137, v137
    s_nop 0
    v_add_f32 v137, 1.0, v137
    v_rcp_f32 v137, v137
    s_nop 0
    v_mul_f32 v136, v136, v137
    v_cvt_pk_bf16_f32 v136, v136, v136
    ds_write_b16 v26, v136
    s_waitcnt lgkmcnt(0)
    s_mov_b32 exec_lo, 0x110011
    s_mov_b32 exec_hi, 0x110011
    ds_read_b128 v[40:43], v27
    s_mov_b32 exec_lo, 0x220022
    s_mov_b32 exec_hi, 0x220022
    ds_read_b128 v[44:47], v27
    s_mov_b32 exec_lo, 0x440044
    s_mov_b32 exec_hi, 0x440044
    ds_read_b128 v[48:51], v27
    s_mov_b32 exec_lo, 0x880088
    s_mov_b32 exec_hi, 0x880088
    ds_read_b128 v[52:55], v27
    s_mov_b32 exec_lo, 0x11001100
    s_mov_b32 exec_hi, 0x11001100
    ds_read_b128 v[56:59], v27
    s_mov_b32 exec_lo, 0x22002200
    s_mov_b32 exec_hi, 0x22002200
    ds_read_b128 v[60:63], v27
    s_mov_b32 exec_lo, 0x44004400
    s_mov_b32 exec_hi, 0x44004400
    ds_read_b128 v[64:67], v27
    s_mov_b32 exec_lo, 0x88008800
    s_mov_b32 exec_hi, 0x88008800
    ds_read_b128 v[68:71], v27
    s_mov_b64 exec, -1
    s_waitcnt lgkmcnt(7)
    v_mfma_f32_16x16x32_bf16 v[136:139], v[40:43], v[104:107], 0
    s_waitcnt lgkmcnt(6)
    v_mfma_f32_16x16x32_bf16 v[136:139], v[44:47], v[108:111], v[136:139]
    s_waitcnt lgkmcnt(5)
    v_mfma_f32_16x16x32_bf16 v[136:139], v[48:51], v[112:115], v[136:139]
    s_waitcnt lgkmcnt(4)
    v_mfma_f32_16x16x32_bf16 v[136:139], v[52:55], v[116:119], v[136:139]
    s_waitcnt lgkmcnt(3)
    v_mfma_f32_16x16x32_bf16 v[136:139], v[56:59], v[120:123], v[136:139]
    s_waitcnt lgkmcnt(2)
    v_mfma_f32_16x16x32_bf16 v[136:139], v[60:63], v[124:127], v[136:139]
    s_waitcnt lgkmcnt(1)
    v_mfma_f32_16x16x32_bf16 v[136:139], v[64:67], v[128:131], v[136:139]
    s_waitcnt lgkmcnt(0)
    v_mfma_f32_16x16x32_bf16 v[136:139], v[68:71], v[132:135], v[136:139]
    s_nop 7
    v_bfi_b32 v136, s83, v13, v136
    v_bfi_b32 v137, s83, v13, v137
    v_bfi_b32 v138, s83, v13, v138
    v_bfi_b32 v139, s83, v13, v139
    buffer_store_dwordx4 v[136:139], v28, s[52:55], s14 offen sc1
    s_cmp_ge_u32 s7, 8
    s_cbranch_scc1 L_fin
    s_mov_b32 s68, s40
    s_mov_b32 s69, s41
    s_mov_b32 s70, 4096
    s_mov_b32 s71, 0x20000
    s_mul_i32 s11, s3, 114688
    s_add_u32 s11, s11, s75
    s_add_u32 s11, s11, 3145728
    s_add_u32 s15, s11, 65536
    s_lshl_b32 s9, s3, 2
    s_add_u32 s9, s9, 112640
    v_lshl_add_u32 v9, v11, 5, s9
    v_lshlrev_b32 v8, 5, v11
    v_add_u32 v8, 112640, v8
    s_lshr_b32 s10, s75, 1
    v_lshlrev_b32 v10, 1, v11
    v_mov_b32 v44, 0
    v_mov_b32 v45, 0
    v_mov_b32 v46, 0
    v_mov_b32 v47, 0
    s_mov_b32 s94, -1
    s_mov_b32 s95, 0xffff
    s_waitcnt vmcnt(0)
    s_mov_b32 s81, 200007
Lpoll_68:
    buffer_load_dwordx4 v[40:43], v0, s[52:55], s11 offen sc1
    s_and_saveexec_b64 s[84:85], s[94:95]
    buffer_load_dwordx4 v[44:47], v0, s[52:55], s15 offen sc1
Lchk_70:
    s_waitcnt vmcnt(0)
    v_xor_b32 v44, v13, v44
    v_xor_b32 v45, v13, v45
    v_xor_b32 v46, v13, v46
    v_xor_b32 v47, v13, v47
    s_mov_b64 exec, s[84:85]
    v_xor_b32 v40, v13, v40
    v_xor_b32 v41, v13, v41
    v_xor_b32 v42, v13, v42
    v_xor_b32 v43, v13, v43
    v_or_b32 v12, v40, v41
    v_or3_b32 v12, v12, v42, v43
    v_or3_b32 v12, v12, v44, v45
    v_or3_b32 v12, v12, v46, v47
    v_and_b32 v12, s83, v12
    v_cmp_ne_u32 vcc, 0, v12
    s_cbranch_vccz Ldone_69
    s_mov_b64 exec, vcc
    s_sub_u32 s81, s81, 1
    s_cbranch_scc0 Lpoll_68
Ldone_69:
    s_mov_b64 exec, -1
    v_pk_add_f32 v[40:41], v[40:41], v[44:45]
    v_pk_add_f32 v[42:43], v[42:43], v[46:47]
    s_nop 0
    v_permlane32_swap_b32 v40, v41
    v_permlane32_swap_b32 v42, v43
    v_add_f32 v40, v40, v41
    v_add_f32 v42, v42, v43
    s_nop 1
    v_permlane16_swap_b32 v40, v42
    v_add_f32 v40, v40, v42
    s_nop 1
    v_add_f32_dpp v40, v40, v40 row_ror:8 row_mask:0xf bank_mask:0xf
    ds_write_b32 v9, v40
    s_waitcnt lgkmcnt(0)
    s_barrier
    s_cmp_lg_u32 s3, 7
    s_cbranch_scc1 L_fin
    ds_read_b128 v[40:43], v8
    ds_read_b128 v[44:47], v8 offset:16
    s_waitcnt lgkmcnt(0)
    v_pk_add_f32 v[40:41], v[40:41], v[44:45]
    v_pk_add_f32 v[42:43], v[42:43], v[46:47]
    v_add_f32 v40, v40, v41
    v_add_f32 v42, v42, v43
    v_add_f32 v40, v40, v42
    v_cvt_pk_bf16_f32 v40, v40, v40
    v_lshlrev_b32 v40, 16, v40
    v_add_f32 v40, v6, v40
    v_cvt_pk_bf16_f32 v40, v40, v40
    v_lshlrev_b32 v40, 16, v40
    v_mul_f32 v40, v15, v40
    v_cvt_pk_bf16_f32 v40, v40, v40
    v_lshlrev_b32 v40, 16, v40
    v_add_f32 v40, v5, v40
    v_cvt_pk_bf16_f32 v40, v40, v40
    s_mov_b32 exec_lo, 0x00ff00ff
    s_mov_b32 exec_hi, 0x00ff00ff
    buffer_store_short v40, v10, s[68:71], s10 offen
    s_mov_b64 exec, -1
    s_branch L_fin
L_tailB:
    s_cmp_ge_u32 s86, 112
    s_cbranch_scc1 L_fin
    v_lshrrev_b32 v7, 4, v1
    s_and_b32 s9, s86, 3
    s_lshl_b32 s13, s9, 10
    s_lshl_b32 s10, s3, 12
    s_add_u32 s13, s13, s10
    s_add_u32 s15, s13, 45056
    s_add_u32 s88, s13, 53248
    s_mul_i32 s74, s13, 33
    s_add_u32 s74, s74, 1572864
    v_lshrrev_b32 v6, 1, v1
    v_and_b32 v5, 1, v1
    v_lshlrev_b32 v20, 7, v6
    v_lshl_add_u32 v20, v5, 4, v20
    v_mul_u32_u24 v21, 4224, v6
    v_lshl_add_u32 v21, v5, 4, v21
    s_add_u32 s89, s10, 565248
    s_mul_i32 s91, s3, 135168
    s_add_u32 s91, s91, 1574912
    s_mul_i32 s10, s3, 576
    s_add_u32 s10, s10, 104448
    v_lshl_add_u32 v22, v1, 3, s10
    v_lshlrev_b32 v23, 9, v5
    v_lshl_add_u32 v24, v7, 4, v23
    v_mul_u32_u24 v23, 576, v5
    v_lshl_add_u32 v23, v7, 4, v23
    v_add_u32 v23, 104448, v23
    s_lshl_b32 s90, s86, 10
    s_lshl_b32 s9, s3, 6
    s_add_u32 s90, s90, s9
    s_add_u32 s90, s90, 917504
    v_bfe_u32 v25, v1, 2, 2
    v_lshl_add_u32 v25, v7, 3, v25
    v_lshlrev_b32 v25, 8, v25
    v_and_b32 v6, 3, v1
    v_lshl_add_u32 v25, v6, 3, v25
    s_lshl_b32 s9, s3, 5
    v_add_u32 v25, s9, v25
    v_bfe_u32 v6, v1, 2, 3
    v_lshlrev_b32 v6, 5, v6
    v_xor_b32 v25, v25, v6
    v_lshrrev_b32 v6, 3, v1
    v_and_b32 v8, 7, v1
    v_mul_u32_u24 v26, 4224, v6
    v_lshl_add_u32 v26, v8, 4, v26
    s_barrier
    s_cmp_ge_u32 s3, 2
    s_cbranch_scc1 L_nocst
    s_mov_b32 s81, 200007
Lpoll_71:
    buffer_load_dwordx4 v[36:39], v3, s[52:55], s15 offen sc1
    buffer_load_dwordx4 v[16:19], v3, s[52:55], s88 offen sc1
    buffer_load_dwordx4 v[136:139], v20, s[52:55], s89 offen sc1
Lchk_73:
    s_waitcnt vmcnt(0)
    v_xor_b32 v36, v13, v36
    v_xor_b32 v37, v13, v37
    v_xor_b32 v38, v13, v38
    v_xor_b32 v39, v13, v39
    v_xor_b32 v16, v13, v16
    v_xor_b32 v17, v13, v17
    v_xor_b32 v18, v13, v18
    v_xor_b32 v19, v13, v19
    v_or_b32 v12, v36, v37
    v_or3_b32 v12, v12, v38, v39
    v_or3_b32 v12, v12, v16, v17
    v_or3_b32 v12, v12, v18, v19
    v_and_b32 v12, s83, v12
    v_xor_b32 v139, s82, v139
    v_or_b32 v12, v12, v139
    v_cmp_ne_u32 vcc, 0, v12
    s_cbranch_vccz Ldone_72
    s_mov_b64 exec, vcc
    s_sub_u32 s81, s81, 1
    s_cbranch_scc0 Lpoll_71
Ldone_72:
    s_mov_b64 exec, -1
    v_permlane32_swap_b32 v136, v137
    v_permlane32_swap_b32 v138, v139
    v_add_f32 v136, v136, v137
    v_add_f32 v138, v138, v139
    s_nop 1
    v_permlane16_swap_b32 v136, v138
    v_add_f32 v136, v136, v138
    s_nop 1
    v_add_f32_dpp v136, v136, v136 row_ror:2 row_mask:0xf bank_mask:0xf
    s_nop 1
    v_add_f32_dpp v136, v136, v136 row_ror:4 row_mask:0xf bank_mask:0xf
    s_nop 1
    v_add_f32_dpp v136, v136, v136 row_ror:8 row_mask:0xf bank_mask:0xf
    v_mul_f32 v136, 0x3a800000, v136
    s_nop 0
    v_readlane_b32 s9, v136, 0
    s_nop 1
    v_mov_b32 v144, s9
    v_readlane_b32 s9, v136, 32
    s_nop 1
    v_mov_b32 v145, s9
    v_readlane_b32 s9, v136, 16
    s_nop 1
    v_mov_b32 v146, s9
    v_readlane_b32 s9, v136, 1
    s_nop 1
    v_mov_b32 v147, s9
    v_readlane_b32 s9, v136, 33
    s_nop 1
    v_mov_b32 v148, s9
L_nocst:
Lca_74:
    v_mov_b32 v4, 111616
    v_mov_b32 v5, 1
    s_mov_b64 exec, 1
    ds_add_rtn_u32 v5, v4, v5 offset:16
    s_mov_b64 exec, -1
    s_waitcnt lgkmcnt(0)
    v_readfirstlane_b32 s21, v5
    s_nop 0
    s_cmp_ge_u32 s21, s20
    s_cbranch_scc1 Lcad_75
    s_lshl_b32 m0, s21, 10
    s_mul_i32 s9, s21, s19
    s_add_u32 s9, s9, s18
    s_lshr_b32 s22, s21, 1
    s_and_b32 s22, s22, s16
    s_lshl_b32 s22, s22, 5
    s_lshr_b32 s21, s21, s17
    s_and_b32 s21, s21, 1
    s_lshl_b32 s21, s21, 7
    s_or_b32 s22, s22, s21
    v_xor_b32 v4, s22, v2
    buffer_load_dwordx4 v4, s[64:67], s9 offen nt lds
    s_branch Lca_74
Lcad_75:
    s_waitcnt vmcnt(0)
    s_barrier
    ds_read_b64_tr_b16 v[72:73], v25 offset:0
    ds_read_b64_tr_b16 v[74:75], v25 offset:1024
    ds_read_b64_tr_b16 v[76:77], v25 offset:8192
    ds_read_b64_tr_b16 v[78:79], v25 offset:9216
    ds_read_b64_tr_b16 v[80:81], v25 offset:16384
    ds_read_b64_tr_b16 v[82:83], v25 offset:17408
    ds_read_b64_tr_b16 v[84:85], v25 offset:24576
    ds_read_b64_tr_b16 v[86:87], v25 offset:25600
    ds_read_b64_tr_b16 v[88:89], v25 offset:32768
    ds_read_b64_tr_b16 v[90:91], v25 offset:33792
    ds_read_b64_tr_b16 v[92:93], v25 offset:40960
    ds_read_b64_tr_b16 v[94:95], v25 offset:41984
    ds_read_b64_tr_b16 v[96:97], v25 offset:49152
    ds_read_b64_tr_b16 v[98:99], v25 offset:50176
    ds_read_b64_tr_b16 v[100:101], v25 offset:57344
    ds_read_b64_tr_b16 v[102:103], v25 offset:58368
    s_cmp_ge_u32 s3, 2
    s_cbranch_scc1 L_ydone
    s_lshl_b32 s10, s5, 7
    s_add_u32 s10, s10, 589824
    s_mov_b64 exec, 0xff
    s_mov_b32 s81, 200007
Lpoll_76:
    buffer_load_dwordx4 v[32:35], v3, s[52:55], s10 offen sc1
Lchk_78:
    s_waitcnt vmcnt(0)
    v_xor_b32 v32, v13, v32
    v_xor_b32 v33, v13, v33
    v_xor_b32 v34, v13, v34
    v_xor_b32 v35, v13, v35
    v_or_b32 v12, v32, v33
    v_or3_b32 v12, v12, v34, v35
    v_and_b32 v12, s83, v12
    v_cmp_ne_u32 vcc, 0, v12
    s_cbranch_vccz Ldone_77
    s_mov_b64 exec, vcc
    s_sub_u32 s81, s81, 1
    s_cbranch_scc0 Lpoll_76
Ldone_77:
    s_mov_b64 exec, -1
    s_mov_b32 s81, 200007
Lpoll_79:
    buffer_load_dwordx4 v[32:35], v26, s[52:55], s74 offen sc1
    buffer_load_dwordx4 v[136:139], v21, s[52:55], s91 offen sc1
Lchk_81:
    s_waitcnt vmcnt(0)
    v_xor_b32 v32, v13, v32
    v_xor_b32 v33, v13, v33
    v_xor_b32 v34, v13, v34
    v_xor_b32 v35, v13, v35
    v_or_b32 v12, v32, v33
    v_or3_b32 v12, v12, v34, v35
    v_and_b32 v12, s83, v12
    v_xor_b32 v139, s82, v139
    v_or_b32 v12, v12, v139
    v_cmp_ne_u32 vcc, 0, v12
    s_cbranch_vccz Ldone_80
    s_mov_b64 exec, vcc
    s_sub_u32 s81, s81, 1
    s_cbranch_scc0 Lpoll_79
Ldone_80:
    s_mov_b64 exec, -1
    v_permlane32_swap_b32 v136, v137
    v_permlane32_swap_b32 v138, v139
    v_add_f32 v136, v136, v137
    v_add_f32 v138, v138, v139
    s_nop 1
    v_permlane16_swap_b32 v136, v138
    v_add_f32 v136, v136, v138
    s_nop 1
    v_add_f32_dpp v136, v136, v136 row_ror:2 row_mask:0xf bank_mask:0xf
    s_nop 1
    v_add_f32_dpp v136, v136, v136 row_ror:4 row_mask:0xf bank_mask:0xf
    s_nop 1
    v_add_f32_dpp v136, v136, v136 row_ror:8 row_mask:0xf bank_mask:0xf
    v_mul_f32 v136, 0x3a800000, v136
    s_nop 0
    v_readlane_b32 s10, v136, 0
    v_readlane_b32 s11, v136, 32
    v_readlane_b32 s12, v136, 16
    v_readlane_b32 s13, v136, 1
    v_readlane_b32 s15, v136, 33
    v_readlane_b32 s88, v136, 17
    v_mov_b32 v5, s10
    v_mov_b32 v6, s11
    v_fma_f32 v6, -v5, v5, v6
    v_max_f32 v6, 0, v6
    v_cvt_pk_bf16_f32 v60, v5, v6
    v_and_b32 v6, s78, v60
    v_lshlrev_b32 v140, 16, v60
    v_add_f32 v6, 0x3727c5ac, v6
    v_cvt_pk_bf16_f32 v6, v6, v6
    v_lshlrev_b32 v6, 16, v6
    v_sqrt_f32 v6, v6
    s_nop 0
    v_cvt_pk_bf16_f32 v6, v6, v6
    v_lshlrev_b32 v6, 16, v6
    v_rcp_f32 v141, v6
    v_fma_f32 v150, -v140, v144, s12
    v_mul_f32 v151, v140, v145
    v_fma_f32 v151, -2.0, s15, v151
    v_fma_f32 v151, v140, v151, s13
    v_fma_f32 v152, -v140, v146, s88
    v_pk_add_f32 v[32:33], v[32:33], v[140:141] op_sel:[0,0] op_sel_hi:[1,0] neg_lo:[0,1] neg_hi:[0,1]
    v_pk_add_f32 v[34:35], v[34:35], v[140:141] op_sel:[0,0] op_sel_hi:[1,0] neg_lo:[0,1] neg_hi:[0,1]
    v_cvt_pk_bf16_f32 v60, v32, v33
    v_lshlrev_b32 v32, 16, v60
    v_and_b32 v33, s78, v60
    v_cvt_pk_bf16_f32 v61, v34, v35
    v_lshlrev_b32 v34, 16, v61
    v_and_b32 v35, s78, v61
    v_fma_f32 v5, v141, v150, v147
    v_mul_f32 v151, v141, v151
    v_fma_f32 v151, 2.0, v152, v151
    v_fma_f32 v6, v141, v151, v148
    v_pk_mul_f32 v[32:33], v[32:33], v[140:141] op_sel:[0,1] op_sel_hi:[1,1]
    v_pk_mul_f32 v[34:35], v[34:35], v[140:141] op_sel:[0,1] op_sel_hi:[1,1]
    v_cvt_pk_bf16_f32 v60, v32, v33
    v_lshlrev_b32 v32, 16, v60
    v_and_b32 v33, s78, v60
    v_cvt_pk_bf16_f32 v61, v34, v35
    v_lshlrev_b32 v34, 16, v61
    v_and_b32 v35, s78, v61
    v_fma_f32 v6, -v5, v5, v6
    v_max_f32 v6, 0, v6
    v_cvt_pk_bf16_f32 v62, v5, v6
    v_and_b32 v6, s78, v62
    v_lshlrev_b32 v142, 16, v62
    v_add_f32 v6, 0x3727c5ac, v6
    v_cvt_pk_bf16_f32 v6, v6, v6
    v_lshlrev_b32 v6, 16, v6
    v_sqrt_f32 v6, v6
    s_nop 0
    v_cvt_pk_bf16_f32 v6, v6, v6
    v_lshlrev_b32 v6, 16, v6
    v_rcp_f32 v143, v6
    v_pk_mul_f32 v[32:33], v[32:33], v[16:17]
    v_pk_mul_f32 v[34:35], v[34:35], v[18:19]
    v_cvt_pk_bf16_f32 v60, v32, v33
    v_lshlrev_b32 v32, 16, v60
    v_and_b32 v33, s78, v60
    v_cvt_pk_bf16_f32 v61, v34, v35
    v_lshlrev_b32 v34, 16, v61
    v_and_b32 v35, s78, v61
    v_pk_add_f32 v[32:33], v[32:33], v[36:37]
    v_pk_add_f32 v[34:35], v[34:35], v[38:39]
    v_cvt_pk_bf16_f32 v60, v32, v33
    v_lshlrev_b32 v32, 16, v60
    v_and_b32 v33, s78, v60
    v_cvt_pk_bf16_f32 v61, v34, v35
    v_lshlrev_b32 v34, 16, v61
    v_and_b32 v35, s78, v61
    v_pk_add_f32 v[32:33], v[32:33], v[142:143] op_sel:[0,0] op_sel_hi:[1,0] neg_lo:[0,1] neg_hi:[0,1]
    v_pk_add_f32 v[34:35], v[34:35], v[142:143] op_sel:[0,0] op_sel_hi:[1,0] neg_lo:[0,1] neg_hi:[0,1]
    v_cvt_pk_bf16_f32 v60, v32, v33
    v_lshlrev_b32 v32, 16, v60
    v_and_b32 v33, s78, v60
    v_cvt_pk_bf16_f32 v61, v34, v35
    v_lshlrev_b32 v34, 16, v61
    v_and_b32 v35, s78, v61
    v_pk_mul_f32 v[32:33], v[32:33], v[142:143] op_sel:[0,1] op_sel_hi:[1,1]
    v_pk_mul_f32 v[34:35], v[34:35], v[142:143] op_sel:[0,1] op_sel_hi:[1,1]
    v_cvt_pk_bf16_f32 v28, v32, v33
    v_cvt_pk_bf16_f32 v29, v34, v35
    ds_write_b64 v22, v[28:29]
    s_waitcnt lgkmcnt(0)
L_ydone:
    s_barrier
    ds_read_b128 v[136:139], v23 offset:0
    ds_read_b128 v[140:143], v23 offset:64
    ds_read_b128 v[144:147], v23 offset:128
    ds_read_b128 v[148:151], v23 offset:192
    ds_read_b128 v[152:155], v23 offset:256
    ds_read_b128 v[156:159], v23 offset:320
    ds_read_b128 v[160:163], v23 offset:384
    ds_read_b128 v[164:167], v23 offset:448
    s_waitcnt lgkmcnt(7)
    v_mfma_f32_16x16x32_bf16 v[32:35], v[72:75], v[136:139], 0
    s_waitcnt lgkmcnt(6)
    v_mfma_f32_16x16x32_bf16 v[32:35], v[76:79], v[140:143], v[32:35]
    s_waitcnt lgkmcnt(5)
    v_mfma_f32_16x16x32_bf16 v[32:35], v[80:83], v[144:147], v[32:35]
    s_waitcnt lgkmcnt(4)
    v_mfma_f32_16x16x32_bf16 v[32:35], v[84:87], v[148:151], v[32:35]
    s_waitcnt lgkmcnt(3)
    v_mfma_f32_16x16x32_bf16 v[32:35], v[88:91], v[152:155], v[32:35]
    s_waitcnt lgkmcnt(2)
    v_mfma_f32_16x16x32_bf16 v[32:35], v[92:95], v[156:159], v[32:35]
    s_waitcnt lgkmcnt(1)
    v_mfma_f32_16x16x32_bf16 v[32:35], v[96:99], v[160:163], v[32:35]
    s_waitcnt lgkmcnt(0)
    v_mfma_f32_16x16x32_bf16 v[32:35], v[100:103], v[164:167], v[32:35]
    s_mov_b32 exec_lo, 0x00030003
    s_mov_b32 exec_hi, 0x00030003
    s_nop 5
    v_bfi_b32 v32, s83, v13, v32
    v_bfi_b32 v33, s83, v13, v33
    v_bfi_b32 v34, s83, v13, v34
    v_bfi_b32 v35, s83, v13, v35
    s_cmp_eq_u32 s101, 1
    s_cbranch_scc1 Lsg_82
    buffer_store_dwordx4 v[32:35], v24, s[52:55], s90 offen sc1
    s_branch Lsgd_83
Lsg_82:
    buffer_store_dwordx4 v[32:35], v24, s[52:55], s90 offen
Lsgd_83:
    s_mov_b64 exec, -1
L_fin:
L_end:
    s_endpgm
.section .rodata,"a"
.p2align 6
.amdhsa_kernel adaLN_cond__gqa_block_cached__mixer_channel_mlp__decode_kernel
.amdhsa_next_free_vgpr 168
.amdhsa_next_free_sgpr 102
.amdhsa_accum_offset 168
.amdhsa_group_segment_fixed_size 0
.amdhsa_kernarg_size 120
.amdhsa_user_sgpr_count 2
.amdhsa_user_sgpr_kernarg_segment_ptr 1
.amdhsa_system_sgpr_workgroup_id_x 1
.amdhsa_float_denorm_mode_32 3
.end_amdhsa_kernel
```
